```python
import torch

def _softmax(x, axis=-1):
    return torch.softmax(x, dim=axis)
def _gelu(x):
    return torch.nn.functional.gelu(x, approximate="tanh")
def _silu(x):
    return torch.nn.functional.silu(x)
def _sigmoid(x):
    return torch.sigmoid(x)
def _layernorm(x, axis=-1, eps=1e-5):
    m = x.mean(dim=axis, keepdim=True)
    v = x.var(dim=axis, keepdim=True, unbiased=False)
    return (x - m) / torch.sqrt(v + eps)
def _scatter_add(tgt, idx, src, axis=0):
    return tgt.clone().index_add_(axis, idx, src)
def _segment_sum(src, seg, n):
    out = torch.zeros((n,) + src.shape[1:], dtype=src.dtype)
    return out.index_add_(0, seg, src)
def _pad(x, pw):
    flat = tuple(v for pair in reversed(pw) for v in pair)
    return torch.nn.functional.pad(x, flat)

kernel_name = 'gated_mix__grouped_kv_mqa__ssm_conv_s5__prompt'

def setup_inputs():

    _w = (lambda a: (lambda t: t.to(torch.bfloat16) if t.is_floating_point() else t)(torch.as_tensor(a)))
    def _A_setup():
        B, S, D, H = 1, 2048, 448, 16
        Dh = D // H
        return {
            "x": _w((lambda *s: torch.randn(*s, dtype=torch.bfloat16) * 0.05)(B, S, D)),
            "wq": _w((lambda *s: torch.randn(*s, dtype=torch.bfloat16) * 1.6)(D, H * Dh)),
            "wk": _w((lambda *s: torch.randn(*s, dtype=torch.bfloat16) * 1.6)(D, Dh)),
            "wv": _w((lambda *s: torch.randn(*s, dtype=torch.bfloat16) * 0.05)(D, Dh)),
            "wo": _w((lambda *s: torch.randn(*s, dtype=torch.bfloat16) * 0.05)(H * Dh, D)),
        }
    _A_in = _A_setup()

    def _B_setup():
        B, S, D = 1, 2048, 448
        P = D
        Lambda_re = -0.5 * (lambda _x: torch.exp(torch.as_tensor(_x)))((lambda *s: torch.randn(*s, dtype=torch.bfloat16) * 0.4)(P))
        Lambda_im = (lambda *s: torch.randn(*s, dtype=torch.bfloat16) * 0.8)(P) * 1.0
        B_re = (lambda *s: torch.randn(*s, dtype=torch.bfloat16) * 0.4)(P, D) * (D ** -0.5)
        B_im = (lambda *s: torch.randn(*s, dtype=torch.bfloat16) * 0.4)(P, D) * (D ** -0.5)
        C_re = (lambda *s: torch.randn(*s, dtype=torch.bfloat16) * 0.4)(D, P) * (P ** -0.5)
        C_im = (lambda *s: torch.randn(*s, dtype=torch.bfloat16) * 0.4)(D, P) * (P ** -0.5)
        log_dt = (lambda *s: torch.randn(*s, dtype=torch.bfloat16) * 0.4)(P) * 0.3 - 2.0
        Dskip = (lambda *s: torch.randn(*s, dtype=torch.bfloat16) * 0.2)(D)
        return {
            "x": _w((lambda *s: torch.randn(*s, dtype=torch.bfloat16) * 0.05)(B, S, D)),
            "Lambda_re": _w(Lambda_re),
            "Lambda_im": _w(Lambda_im),
            "B_re": _w(B_re),
            "B_im": _w(B_im),
            "C_re": _w(C_re),
            "C_im": _w(C_im),
            "log_dt": _w(log_dt),
            "Dskip": _w(Dskip),
        }
    _B_in = _B_setup()

    return {
        "A_x": _A_in["x"],
        "A_wq": _A_in["wq"],
        "A_wk": _A_in["wk"],
        "A_wv": _A_in["wv"],
        "A_wo": _A_in["wo"],
        "B_x": _B_in["x"],
        "B_Lambda_re": _B_in["Lambda_re"],
        "B_Lambda_im": _B_in["Lambda_im"],
        "B_B_re": _B_in["B_re"],
        "B_B_im": _B_in["B_im"],
        "B_C_re": _B_in["C_re"],
        "B_C_im": _B_in["C_im"],
        "B_log_dt": _B_in["log_dt"],
        "B_Dskip": _B_in["Dskip"],
        "gate_w": _w((lambda *s: torch.randn(*s, dtype=torch.bfloat16) * 0.05)(448) * 16.0),
    }

def reference(A_x, A_wq, A_wk, A_wv, A_wo, B_x, B_Lambda_re, B_Lambda_im, B_B_re, B_B_im, B_C_re, B_C_im, B_log_dt, B_Dskip, gate_w):
    def _A_ref(x, wq, wk, wv, wo):
        B, S, D = x.shape
        H = 16
        Dh = D // H
        q = (lambda x, *d: x.permute(*d))((x @ wq).reshape(B, S, H, Dh), 0, 2, 1, 3)
        k = x @ wk
        v = x @ wv
        scores = torch.einsum("bhqd,bkd->bhqk", q, k) * (Dh ** -0.5)
        p = _softmax(scores, axis=-1)
        o = torch.einsum("bhqk,bkd->bhqd", p, v)
        return (lambda x, *d: x.permute(*d))(o, 0, 2, 1, 3).reshape(B, S, H * Dh) @ wo

    def _B_ref(x, Lambda_re, Lambda_im, B_re, B_im, C_re, C_im, log_dt, Dskip):
        Bsz, L, H = x.shape
        Lam = Lambda_re + 1j * Lambda_im
        Bmat = B_re + 1j * B_im
        Cmat = C_re + 1j * C_im
        dt = torch.exp(log_dt)
        Lam_bar = torch.exp(dt * Lam)
        B_bar = ((Lam_bar - 1.0) / Lam)[:, None] * Bmat
        Bu = torch.einsum("bld,pd->blp", x + 0j, B_bar)
        h = torch.zeros_like(Bu[:, 0, :])
        hs = []
        for t in range(L):
            h = Lam_bar[None, :] * h + Bu[:, t, :]
            hs.append(h)
        hseq = torch.stack(hs, 1)
        y = 2.0 * torch.einsum("blp,dp->bld", hseq, Cmat).real + x * Dskip[None, None, :]
        return y

    x = A_x
    g = _sigmoid((x * gate_w).sum(-1, keepdims=True))
    a = _A_ref(x, A_wq, A_wk, A_wv, A_wo)
    b = _B_ref(x, B_Lambda_re, B_Lambda_im, B_B_re, B_B_im, B_C_re, B_C_im, B_log_dt, B_Dskip)
    return g * a + (1 - g) * b
```

```asm
; @launch grid=(256,1,1) block=(768,1,1) lds=163840
.amdgcn_target "amdgcn-amd-amdhsa--gfx950"
.text
.globl gated_mix__grouped_kv_mqa__ssm_conv_s5__prompt_kernel
.p2align 8
.type gated_mix__grouped_kv_mqa__ssm_conv_s5__prompt_kernel,@function
gated_mix__grouped_kv_mqa__ssm_conv_s5__prompt_kernel:
    s_cmp_ge_u32 s2, 256
    s_cbranch_scc1 L_end
    s_load_dwordx16 s[64:79], s[0:1], 0
    s_load_dwordx16 s[80:95], s[0:1], 64
    s_load_dwordx4 s[96:99], s[0:1], 128
    s_getpc_b64 s[56:57]
p0_pc0:
    v_lshlrev_b32 v148, 7, v0
    s_mov_b32 s3, L_end-p0_pc0
    v_min_u32 v148, s3, v148
    global_load_dword v149, v148, s[56:57]
    v_lshrrev_b32 v2, 6, v0
    v_and_b32 v0, 63, v0
    v_readfirstlane_b32 s22, v2
    v_mov_b32 v4, 163584
    v_mov_b32 v5, 0
    v_lshl_add_u32 v4, v0, 2, v4
    ds_write_b32 v4, v5
    s_and_b32 s20, s2, 7
    s_lshl_b32 s20, s20, 2
    s_lshr_b32 s21, s2, 3
    s_and_b32 s3, s21, 3
    s_add_u32 s20, s20, s3
    s_lshr_b32 s21, s21, 2
    v_lshlrev_b32 v1, 4, v0
    s_mov_b32 s18, 0x100000
    s_sub_u32 s23, s22, 8
    v_lshrrev_b32 v4, 4, v0
    v_and_b32 v5, 1, v4
    v_lshlrev_b32 v5, 4, v5
    v_lshrrev_b32 v3, 5, v0
    v_lshl_add_u32 v5, v3, 2, v5
    v_bfe_u32 v3, v0, 2, 2
    v_add_u32 v5, v5, v3
    v_mul_u32_u24 v5, 896, v5
    v_and_b32 v3, 3, v0
    v_xor_b32 v3, v3, v4
    v_lshl_add_u32 v3, v3, 4, v5
    s_waitcnt lgkmcnt(0)
    s_mov_b32 s24, s98
    s_mov_b32 s25, s99
    s_mov_b32 s26, 0x1000000
    s_mov_b32 s27, 0x00020000
    s_cmp_lt_u32 s22, 4
    s_cselect_b64 s[46:47], -1, 0
    s_cmp_eq_u32 s21, 0
    s_cselect_b32 s28, s68, s70
    s_cselect_b32 s29, s69, s71
    s_mov_b32 s30, 25088
    s_mov_b32 s31, 0x00020000
    s_mul_i32 s32, s23, 7168
    s_add_u32 s34, s32, 114688
    s_mov_b32 s33, 1024
    s_mov_b32 s35, 1024
    s_cmp_lt_u32 s21, 2
    s_cselect_b32 s36, 7, 0
    s_cmp_ge_u32 s22, 8
    s_cselect_b32 s36, s36, 0
    v_cndmask_b32 v3, v1, v3, s[46:47]
    s_mul_i32 s40, s20, 57344
    s_lshr_b32 s3, s22, 1
    s_mul_i32 s3, s3, 28672
    s_add_u32 s40, s40, s3
    s_and_b32 s3, s22, 1
    s_mul_i32 s3, s3, 7168
    s_add_u32 s40, s40, s3
    s_lshl_b32 s41, s22, 10
    s_cmp_lt_u32 s22, 4
    s_cselect_b32 s28, s64, s28
    s_cselect_b32 s29, s65, s29
    s_cselect_b32 s30, 1835008, s30
    s_cselect_b32 s32, s40, s32
    s_cselect_b32 s34, s41, s34
    s_cselect_b32 s33, 64, s33
    s_cselect_b32 s35, 4096, s35
    s_cselect_b32 s36, 14, s36
    s_mov_b32 m0, s34
    s_cmp_eq_u32 s36, 0
    s_cbranch_scc1 p0_first_done
p0_first:
    s_sub_u32 s36, s36, 1
    buffer_load_dwordx4 v3, s[28:31], s32 offen lds
    s_add_u32 s32, s32, s33
    s_add_u32 m0, m0, s35
    s_cmp_lg_u32 s36, 0
    s_cbranch_scc1 p0_first
p0_first_done:
    s_cmp_ge_u32 s22, 8
    s_cbranch_scc1 p0_bgw
    s_cmp_ge_u32 s22, 4
    s_cbranch_scc1 p0_kvw
    s_barrier
    v_bfe_u32 v4, v0, 2, 2
    v_lshrrev_b32 v6, 5, v0
    v_xor_b32 v4, v4, v6
    v_lshlrev_b32 v4, 4, v4
    v_and_b32 v6, 31, v0
    v_lshl_add_u32 v6, v6, 6, v4
    v_lshrrev_b32 v12, 5, v0
    v_lshlrev_b32 v12, 3, v12
    v_bfe_u32 v4, v0, 2, 2
    v_add_u32 v12, v12, v4
    v_and_b32 v13, 16, v0
    v_and_b32 v4, 3, v0
    v_lshl_add_u32 v13, v4, 2, v13
    s_lshr_b32 s38, s22, 1
    s_and_b32 s39, s22, 1
    s_lshl_b32 s3, s38, 11
    v_add_u32 v6, s3, v6
    v_xor_b32 v7, 32, v6
    v_lshlrev_b32 v10, 7, v12
    v_lshl_add_u32 v10, v13, 1, v10
    s_mul_i32 s3, s39, 56
    s_add_u32 s3, s3, 57344
    v_add_u32 v10, s3, v10
    s_waitcnt vmcnt(0)
    v_mov_b32 v4, 163584
    v_mov_b32 v5, 1
    s_mov_b64 exec, 1
    ds_add_u32 v4, v5 offset:28
    s_mov_b64 exec, -1
    v_mov_b32 v4, 163584
p0_xr0:
    ds_read_b32 v5, v4 offset:28
    s_waitcnt lgkmcnt(0)
    v_readfirstlane_b32 s3, v5
    s_cmp_ge_u32 s3, 8
    s_cbranch_scc1 p0_xr0_ok
    s_sleep 1
    s_sub_u32 s18, s18, 1
    s_cbranch_scc0 p0_xr0
    s_mov_b32 s18, 0
p0_xr0_ok:
    ds_read_b128 v[56:59], v6 offset:0
    ds_read_b128 v[60:63], v7 offset:0
    ds_read_b128 v[64:67], v6 offset:4096
    ds_read_b128 v[68:71], v7 offset:4096
    ds_read_b128 v[72:75], v6 offset:8192
    ds_read_b128 v[76:79], v7 offset:8192
    ds_read_b128 v[80:83], v6 offset:12288
    ds_read_b128 v[84:87], v7 offset:12288
    ds_read_b128 v[88:91], v6 offset:16384
    ds_read_b128 v[92:95], v7 offset:16384
    ds_read_b128 v[96:99], v6 offset:20480
    ds_read_b128 v[100:103], v7 offset:20480
    s_waitcnt lgkmcnt(2)
    ds_read_b128 v[104:107], v6 offset:24576
    ds_read_b128 v[108:111], v7 offset:24576
    ds_read_b128 v[112:115], v6 offset:28672
    ds_read_b128 v[116:119], v7 offset:28672
    ds_read_b128 v[120:123], v6 offset:32768
    ds_read_b128 v[124:127], v7 offset:32768
    ds_read_b128 v[128:131], v6 offset:36864
    ds_read_b128 v[132:135], v7 offset:36864
    ds_read_b128 v[136:139], v6 offset:40960
    ds_read_b128 v[140:143], v7 offset:40960
    s_waitcnt lgkmcnt(2)
    ds_read_b128 v[144:147], v6 offset:45056
    ds_read_b128 v[148:151], v7 offset:45056
    ds_read_b128 v[152:155], v6 offset:49152
    ds_read_b128 v[156:159], v7 offset:49152
    ds_read_b128 v[160:163], v6 offset:53248
    ds_read_b128 v[164:167], v7 offset:53248
    s_waitcnt lgkmcnt(0)
    v_mov_b32 v4, 163584
    v_mov_b32 v5, 1
    s_mov_b64 exec, 1
    ds_add_u32 v4, v5 offset:84
    s_mov_b64 exec, -1
    v_mov_b32 v4, 163584
p0_wqr:
    ds_read_b32 v5, v4 offset:88
    s_waitcnt lgkmcnt(0)
    v_readfirstlane_b32 s3, v5
    s_cmp_ge_u32 s3, 4
    s_cbranch_scc1 p0_wqr_ok
    s_sleep 2
    s_sub_u32 s18, s18, 1
    s_cbranch_scc0 p0_wqr
    s_mov_b32 s18, 0
p0_wqr_ok:
    ds_read_b64_tr_b16 v[32:33], v10 offset:0
    ds_read_b64_tr_b16 v[34:35], v10 offset:512
    ds_read_b64_tr_b16 v[36:37], v10 offset:2048
    ds_read_b64_tr_b16 v[38:39], v10 offset:2560
    ds_read_b64_tr_b16 v[40:41], v10 offset:4096
    ds_read_b64_tr_b16 v[42:43], v10 offset:4608
    ds_read_b64_tr_b16 v[44:45], v10 offset:6144
    ds_read_b64_tr_b16 v[46:47], v10 offset:6656
    s_waitcnt lgkmcnt(6)
    v_mfma_f32_32x32x16_bf16 v[16:31], v[32:35], v[56:59], 0
    ds_read_b64_tr_b16 v[32:33], v10 offset:8192
    ds_read_b64_tr_b16 v[34:35], v10 offset:8704
    s_waitcnt lgkmcnt(6)
    v_mfma_f32_32x32x16_bf16 v[16:31], v[36:39], v[60:63], v[16:31]
    ds_read_b64_tr_b16 v[36:37], v10 offset:10240
    ds_read_b64_tr_b16 v[38:39], v10 offset:10752
    s_waitcnt lgkmcnt(6)
    v_mfma_f32_32x32x16_bf16 v[16:31], v[40:43], v[64:67], v[16:31]
    ds_read_b64_tr_b16 v[40:41], v10 offset:12288
    ds_read_b64_tr_b16 v[42:43], v10 offset:12800
    s_waitcnt lgkmcnt(6)
    v_mfma_f32_32x32x16_bf16 v[16:31], v[44:47], v[68:71], v[16:31]
    ds_read_b64_tr_b16 v[44:45], v10 offset:14336
    ds_read_b64_tr_b16 v[46:47], v10 offset:14848
    s_waitcnt lgkmcnt(6)
    v_mfma_f32_32x32x16_bf16 v[16:31], v[32:35], v[72:75], v[16:31]
    ds_read_b64_tr_b16 v[32:33], v10 offset:16384
    ds_read_b64_tr_b16 v[34:35], v10 offset:16896
    s_waitcnt lgkmcnt(6)
    v_mfma_f32_32x32x16_bf16 v[16:31], v[36:39], v[76:79], v[16:31]
    ds_read_b64_tr_b16 v[36:37], v10 offset:18432
    ds_read_b64_tr_b16 v[38:39], v10 offset:18944
    s_waitcnt lgkmcnt(6)
    v_mfma_f32_32x32x16_bf16 v[16:31], v[40:43], v[80:83], v[16:31]
    ds_read_b64_tr_b16 v[40:41], v10 offset:20480
    ds_read_b64_tr_b16 v[42:43], v10 offset:20992
    s_waitcnt lgkmcnt(6)
    v_mfma_f32_32x32x16_bf16 v[16:31], v[44:47], v[84:87], v[16:31]
    ds_read_b64_tr_b16 v[44:45], v10 offset:22528
    ds_read_b64_tr_b16 v[46:47], v10 offset:23040
    s_waitcnt lgkmcnt(6)
    v_mfma_f32_32x32x16_bf16 v[16:31], v[32:35], v[88:91], v[16:31]
    ds_read_b64_tr_b16 v[32:33], v10 offset:24576
    ds_read_b64_tr_b16 v[34:35], v10 offset:25088
    s_waitcnt lgkmcnt(6)
    v_mfma_f32_32x32x16_bf16 v[16:31], v[36:39], v[92:95], v[16:31]
    ds_read_b64_tr_b16 v[36:37], v10 offset:26624
    ds_read_b64_tr_b16 v[38:39], v10 offset:27136
    s_waitcnt lgkmcnt(6)
    v_mfma_f32_32x32x16_bf16 v[16:31], v[40:43], v[96:99], v[16:31]
    ds_read_b64_tr_b16 v[40:41], v10 offset:28672
    ds_read_b64_tr_b16 v[42:43], v10 offset:29184
    s_waitcnt lgkmcnt(6)
    v_mfma_f32_32x32x16_bf16 v[16:31], v[44:47], v[100:103], v[16:31]
    ds_read_b64_tr_b16 v[44:45], v10 offset:30720
    ds_read_b64_tr_b16 v[46:47], v10 offset:31232
    s_waitcnt lgkmcnt(6)
    v_mfma_f32_32x32x16_bf16 v[16:31], v[32:35], v[104:107], v[16:31]
    ds_read_b64_tr_b16 v[32:33], v10 offset:32768
    ds_read_b64_tr_b16 v[34:35], v10 offset:33280
    s_waitcnt lgkmcnt(6)
    v_mfma_f32_32x32x16_bf16 v[16:31], v[36:39], v[108:111], v[16:31]
    ds_read_b64_tr_b16 v[36:37], v10 offset:34816
    ds_read_b64_tr_b16 v[38:39], v10 offset:35328
    s_waitcnt lgkmcnt(6)
    v_mfma_f32_32x32x16_bf16 v[16:31], v[40:43], v[112:115], v[16:31]
    ds_read_b64_tr_b16 v[40:41], v10 offset:36864
    ds_read_b64_tr_b16 v[42:43], v10 offset:37376
    s_waitcnt lgkmcnt(6)
    v_mfma_f32_32x32x16_bf16 v[16:31], v[44:47], v[116:119], v[16:31]
    ds_read_b64_tr_b16 v[44:45], v10 offset:38912
    ds_read_b64_tr_b16 v[46:47], v10 offset:39424
    s_waitcnt lgkmcnt(6)
    v_mfma_f32_32x32x16_bf16 v[16:31], v[32:35], v[120:123], v[16:31]
    ds_read_b64_tr_b16 v[32:33], v10 offset:40960
    ds_read_b64_tr_b16 v[34:35], v10 offset:41472
    s_waitcnt lgkmcnt(6)
    v_mfma_f32_32x32x16_bf16 v[16:31], v[36:39], v[124:127], v[16:31]
    ds_read_b64_tr_b16 v[36:37], v10 offset:43008
    ds_read_b64_tr_b16 v[38:39], v10 offset:43520
    s_waitcnt lgkmcnt(6)
    v_mfma_f32_32x32x16_bf16 v[16:31], v[40:43], v[128:131], v[16:31]
    ds_read_b64_tr_b16 v[40:41], v10 offset:45056
    ds_read_b64_tr_b16 v[42:43], v10 offset:45568
    s_waitcnt lgkmcnt(6)
    v_mfma_f32_32x32x16_bf16 v[16:31], v[44:47], v[132:135], v[16:31]
    ds_read_b64_tr_b16 v[44:45], v10 offset:47104
    ds_read_b64_tr_b16 v[46:47], v10 offset:47616
    s_waitcnt lgkmcnt(6)
    v_mfma_f32_32x32x16_bf16 v[16:31], v[32:35], v[136:139], v[16:31]
    ds_read_b64_tr_b16 v[32:33], v10 offset:49152
    ds_read_b64_tr_b16 v[34:35], v10 offset:49664
    s_waitcnt lgkmcnt(6)
    v_mfma_f32_32x32x16_bf16 v[16:31], v[36:39], v[140:143], v[16:31]
    ds_read_b64_tr_b16 v[36:37], v10 offset:51200
    ds_read_b64_tr_b16 v[38:39], v10 offset:51712
    s_waitcnt lgkmcnt(6)
    v_mfma_f32_32x32x16_bf16 v[16:31], v[40:43], v[144:147], v[16:31]
    ds_read_b64_tr_b16 v[40:41], v10 offset:53248
    ds_read_b64_tr_b16 v[42:43], v10 offset:53760
    s_waitcnt lgkmcnt(6)
    v_mfma_f32_32x32x16_bf16 v[16:31], v[44:47], v[148:151], v[16:31]
    ds_read_b64_tr_b16 v[44:45], v10 offset:55296
    ds_read_b64_tr_b16 v[46:47], v10 offset:55808
    s_waitcnt lgkmcnt(6)
    v_mfma_f32_32x32x16_bf16 v[16:31], v[32:35], v[152:155], v[16:31]
    s_waitcnt lgkmcnt(4)
    v_mfma_f32_32x32x16_bf16 v[16:31], v[36:39], v[156:159], v[16:31]
    s_waitcnt lgkmcnt(2)
    v_mfma_f32_32x32x16_bf16 v[16:31], v[40:43], v[160:163], v[16:31]
    s_waitcnt lgkmcnt(0)
    v_mfma_f32_32x32x16_bf16 v[16:31], v[44:47], v[164:167], v[16:31]
    s_mov_b32 s42, 0x3e8b97f6
    s_lshl_b32 s3, s22, 11
    s_add_u32 s3, s3, 147456
    v_add_u32 v12, s3, v1
    s_nop 7
    s_nop 0
    v_mul_f32 v16, s42, v16
    v_mul_f32 v17, s42, v17
    v_mul_f32 v18, s42, v18
    v_mul_f32 v19, s42, v19
    v_mul_f32 v20, s42, v20
    v_mul_f32 v21, s42, v21
    v_mul_f32 v22, s42, v22
    v_mul_f32 v23, s42, v23
    v_mul_f32 v24, s42, v24
    v_mul_f32 v25, s42, v25
    v_mul_f32 v26, s42, v26
    v_mul_f32 v27, s42, v27
    v_mul_f32 v28, s42, v28
    v_mul_f32 v29, s42, v29
    v_mul_f32 v30, s42, v30
    v_mul_f32 v31, s42, v31
    v_cvt_pk_bf16_f32 v32, v16, v17
    v_cvt_pk_bf16_f32 v33, v18, v19
    v_cvt_pk_bf16_f32 v34, v20, v21
    v_cvt_pk_bf16_f32 v35, v22, v23
    v_cvt_pk_bf16_f32 v36, v24, v25
    v_cvt_pk_bf16_f32 v37, v26, v27
    v_cvt_pk_bf16_f32 v38, v28, v29
    v_cvt_pk_bf16_f32 v39, v30, v31
    s_mov_b32 exec_lo, 0
    v_mov_b32 v38, 0
    v_mov_b32 v39, 0
    s_mov_b32 exec_lo, -1
    ds_write_b128 v12, v[32:35]
    ds_write_b128 v12, v[36:39] offset:1024
    s_waitcnt lgkmcnt(0)
    v_mov_b32 v4, 163584
    v_mov_b32 v5, 1
    s_mov_b64 exec, 1
    ds_add_u32 v4, v5 offset:96
    s_mov_b64 exec, -1
    s_branch p1_att
p0_kvw:
    s_sub_u32 s39, s22, 4
    s_cmp_eq_u32 s39, 0
    s_cbranch_scc0 p0_pf_out
    v_lshlrev_b32 v151, 21, v0
    s_mov_b64 exec, 7
    buffer_load_dword v151, v151, s[24:27], 0 offen
    s_mov_b64 exec, -1
p0_pf_out:
    s_cmp_eq_u32 s39, 1
    s_cbranch_scc0 p0_pf_mall
    s_mov_b32 s48, s94
    s_mov_b32 s49, s95
    s_mov_b32 s50, 0x380000
    s_mov_b32 s51, 0x00020000
    v_mul_u32_u24 v151, 0x1c0000, v0
    s_mov_b64 exec, 7
    buffer_load_dword v151, v151, s[48:51], 0 offen
    s_mov_b64 exec, -1
p0_pf_mall:
p0_pf_done:
    s_barrier
    s_cmp_ge_u32 s21, 3
    s_cbranch_scc1 p0_kv_nojob
    s_lshr_b32 s38, s39, 1
    s_and_b32 s39, s39, 1
    s_mov_b32 s15, 0
    s_setprio 3
p0_kv_setup:
    s_mov_b32 s8, s24
    s_mov_b32 s9, s25
    s_cmp_eq_u32 s15, 0
    s_cselect_b32 s10, 16777216, 0
    s_mov_b32 s11, 0x00020000
    v_bfe_u32 v4, v0, 2, 2
    v_lshrrev_b32 v6, 5, v0
    v_xor_b32 v4, v4, v6
    v_lshlrev_b32 v4, 4, v4
    v_and_b32 v6, 31, v0
    v_lshl_add_u32 v6, v6, 6, v4
    v_lshrrev_b32 v12, 5, v0
    v_lshlrev_b32 v12, 3, v12
    v_bfe_u32 v4, v0, 2, 2
    v_add_u32 v12, v12, v4
    v_and_b32 v13, 16, v0
    v_and_b32 v4, 3, v0
    v_lshl_add_u32 v13, v4, 2, v13
    s_lshl_b32 s3, s38, 11
    s_mul_i32 s41, s39, 28672
    s_add_u32 s3, s3, s41
    v_add_u32 v6, s3, v6
    v_xor_b32 v7, 32, v6
    s_mul_i32 s40, s39, 14
    s_cmp_eq_u32 s21, 2
    s_cbranch_scc1 p0_kv_gaddr
    v_mul_u32_u24 v10, 56, v12
    v_lshl_add_u32 v10, v13, 1, v10
    s_mul_i32 s3, s40, 896
    s_add_u32 s3, s3, 114688
    v_add_u32 v10, s3, v10
    v_add_u32 v11, 224, v10
    s_mov_b32 s42, 896
    s_branch p0_kv_addr_done
p0_kv_gaddr:
    v_lshlrev_b32 v10, 3, v12
    s_lshl_b32 s3, s40, 7
    s_add_u32 s3, s3, 114688
    v_add_u32 v10, s3, v10
    v_add_u32 v11, 32, v10
    s_mov_b32 s42, 128
p0_kv_addr_done:
    v_mov_b32 v4, 163584
    s_cmp_lg_u32 s15, 0
    s_cbranch_scc1 p0_xr_ok
p0_xr:
    ds_read_b32 v5, v4 offset:28
    s_waitcnt lgkmcnt(0)
    v_readfirstlane_b32 s3, v5
    s_cmp_ge_u32 s3, 8
    s_cbranch_scc1 p0_xr_ok
    s_sleep 1
    s_sub_u32 s18, s18, 1
    s_cbranch_scc0 p0_xr
    s_mov_b32 s18, 0
p0_xr_ok:
    s_cmp_ge_u32 s21, 1
    s_cbranch_scc1 p0_kv_swap
    ds_read_b128 v[32:35], v6 offset:0
    ds_read_b64_tr_b16 v[88:89], v10
    ds_read_b64_tr_b16 v[90:91], v11
    v_add_u32 v10, s42, v10
    v_add_u32 v11, s42, v11
    ds_read_b128 v[36:39], v7 offset:0
    ds_read_b64_tr_b16 v[92:93], v10
    ds_read_b64_tr_b16 v[94:95], v11
    v_add_u32 v10, s42, v10
    v_add_u32 v11, s42, v11
    ds_read_b128 v[40:43], v6 offset:4096
    ds_read_b64_tr_b16 v[96:97], v10
    ds_read_b64_tr_b16 v[98:99], v11
    v_add_u32 v10, s42, v10
    v_add_u32 v11, s42, v11
    ds_read_b128 v[44:47], v7 offset:4096
    ds_read_b64_tr_b16 v[100:101], v10
    ds_read_b64_tr_b16 v[102:103], v11
    v_add_u32 v10, s42, v10
    v_add_u32 v11, s42, v11
    s_waitcnt lgkmcnt(9)
    v_mfma_f32_32x32x16_bf16 v[16:31], v[88:91], v[32:35], 0
    ds_read_b128 v[48:51], v6 offset:8192
    ds_read_b64_tr_b16 v[104:105], v10
    ds_read_b64_tr_b16 v[106:107], v11
    v_add_u32 v10, s42, v10
    v_add_u32 v11, s42, v11
    s_waitcnt lgkmcnt(9)
    v_mfma_f32_32x32x16_bf16 v[16:31], v[92:95], v[36:39], v[16:31]
    ds_read_b128 v[52:55], v7 offset:8192
    ds_read_b64_tr_b16 v[108:109], v10
    ds_read_b64_tr_b16 v[110:111], v11
    v_add_u32 v10, s42, v10
    v_add_u32 v11, s42, v11
    s_waitcnt lgkmcnt(9)
    v_mfma_f32_32x32x16_bf16 v[16:31], v[96:99], v[40:43], v[16:31]
    ds_read_b128 v[56:59], v6 offset:12288
    ds_read_b64_tr_b16 v[112:113], v10
    ds_read_b64_tr_b16 v[114:115], v11
    v_add_u32 v10, s42, v10
    v_add_u32 v11, s42, v11
    s_waitcnt lgkmcnt(9)
    v_mfma_f32_32x32x16_bf16 v[16:31], v[100:103], v[44:47], v[16:31]
    ds_read_b128 v[60:63], v7 offset:12288
    ds_read_b64_tr_b16 v[116:117], v10
    ds_read_b64_tr_b16 v[118:119], v11
    v_add_u32 v10, s42, v10
    v_add_u32 v11, s42, v11
    s_waitcnt lgkmcnt(9)
    v_mfma_f32_32x32x16_bf16 v[16:31], v[104:107], v[48:51], v[16:31]
    ds_read_b128 v[64:67], v6 offset:16384
    ds_read_b64_tr_b16 v[120:121], v10
    ds_read_b64_tr_b16 v[122:123], v11
    v_add_u32 v10, s42, v10
    v_add_u32 v11, s42, v11
    s_waitcnt lgkmcnt(9)
    v_mfma_f32_32x32x16_bf16 v[16:31], v[108:111], v[52:55], v[16:31]
    ds_read_b128 v[68:71], v7 offset:16384
    ds_read_b64_tr_b16 v[124:125], v10
    ds_read_b64_tr_b16 v[126:127], v11
    v_add_u32 v10, s42, v10
    v_add_u32 v11, s42, v11
    s_waitcnt lgkmcnt(9)
    v_mfma_f32_32x32x16_bf16 v[16:31], v[112:115], v[56:59], v[16:31]
    ds_read_b128 v[72:75], v6 offset:20480
    ds_read_b64_tr_b16 v[128:129], v10
    ds_read_b64_tr_b16 v[130:131], v11
    v_add_u32 v10, s42, v10
    v_add_u32 v11, s42, v11
    s_waitcnt lgkmcnt(9)
    v_mfma_f32_32x32x16_bf16 v[16:31], v[116:119], v[60:63], v[16:31]
    ds_read_b128 v[76:79], v7 offset:20480
    ds_read_b64_tr_b16 v[132:133], v10
    ds_read_b64_tr_b16 v[134:135], v11
    v_add_u32 v10, s42, v10
    v_add_u32 v11, s42, v11
    s_waitcnt lgkmcnt(9)
    v_mfma_f32_32x32x16_bf16 v[16:31], v[120:123], v[64:67], v[16:31]
    ds_read_b128 v[80:83], v6 offset:24576
    ds_read_b64_tr_b16 v[136:137], v10
    ds_read_b64_tr_b16 v[138:139], v11
    v_add_u32 v10, s42, v10
    v_add_u32 v11, s42, v11
    s_waitcnt lgkmcnt(9)
    v_mfma_f32_32x32x16_bf16 v[16:31], v[124:127], v[68:71], v[16:31]
    ds_read_b128 v[84:87], v7 offset:24576
    ds_read_b64_tr_b16 v[140:141], v10
    ds_read_b64_tr_b16 v[142:143], v11
    s_waitcnt lgkmcnt(9)
    v_mfma_f32_32x32x16_bf16 v[16:31], v[128:131], v[72:75], v[16:31]
    s_waitcnt lgkmcnt(6)
    v_mfma_f32_32x32x16_bf16 v[16:31], v[132:135], v[76:79], v[16:31]
    s_waitcnt lgkmcnt(3)
    v_mfma_f32_32x32x16_bf16 v[16:31], v[136:139], v[80:83], v[16:31]
    s_waitcnt lgkmcnt(0)
    v_mfma_f32_32x32x16_bf16 v[16:31], v[140:143], v[84:87], v[16:31]
    s_branch p0_kv_mm_done
p0_kv_swap:
    ds_read_b128 v[32:35], v6 offset:0
    ds_read_b64_tr_b16 v[88:89], v10
    ds_read_b64_tr_b16 v[90:91], v11
    v_add_u32 v10, s42, v10
    v_add_u32 v11, s42, v11
    ds_read_b128 v[36:39], v7 offset:0
    ds_read_b64_tr_b16 v[92:93], v10
    ds_read_b64_tr_b16 v[94:95], v11
    v_add_u32 v10, s42, v10
    v_add_u32 v11, s42, v11
    ds_read_b128 v[40:43], v6 offset:4096
    ds_read_b64_tr_b16 v[96:97], v10
    ds_read_b64_tr_b16 v[98:99], v11
    v_add_u32 v10, s42, v10
    v_add_u32 v11, s42, v11
    ds_read_b128 v[44:47], v7 offset:4096
    ds_read_b64_tr_b16 v[100:101], v10
    ds_read_b64_tr_b16 v[102:103], v11
    v_add_u32 v10, s42, v10
    v_add_u32 v11, s42, v11
    s_waitcnt lgkmcnt(9)
    v_mfma_f32_32x32x16_bf16 v[16:31], v[32:35], v[88:91], 0
    ds_read_b128 v[48:51], v6 offset:8192
    ds_read_b64_tr_b16 v[104:105], v10
    ds_read_b64_tr_b16 v[106:107], v11
    v_add_u32 v10, s42, v10
    v_add_u32 v11, s42, v11
    s_waitcnt lgkmcnt(9)
    v_mfma_f32_32x32x16_bf16 v[16:31], v[36:39], v[92:95], v[16:31]
    ds_read_b128 v[52:55], v7 offset:8192
    ds_read_b64_tr_b16 v[108:109], v10
    ds_read_b64_tr_b16 v[110:111], v11
    v_add_u32 v10, s42, v10
    v_add_u32 v11, s42, v11
    s_waitcnt lgkmcnt(9)
    v_mfma_f32_32x32x16_bf16 v[16:31], v[40:43], v[96:99], v[16:31]
    ds_read_b128 v[56:59], v6 offset:12288
    ds_read_b64_tr_b16 v[112:113], v10
    ds_read_b64_tr_b16 v[114:115], v11
    v_add_u32 v10, s42, v10
    v_add_u32 v11, s42, v11
    s_waitcnt lgkmcnt(9)
    v_mfma_f32_32x32x16_bf16 v[16:31], v[44:47], v[100:103], v[16:31]
    ds_read_b128 v[60:63], v7 offset:12288
    ds_read_b64_tr_b16 v[116:117], v10
    ds_read_b64_tr_b16 v[118:119], v11
    v_add_u32 v10, s42, v10
    v_add_u32 v11, s42, v11
    s_waitcnt lgkmcnt(9)
    v_mfma_f32_32x32x16_bf16 v[16:31], v[48:51], v[104:107], v[16:31]
    ds_read_b128 v[64:67], v6 offset:16384
    ds_read_b64_tr_b16 v[120:121], v10
    ds_read_b64_tr_b16 v[122:123], v11
    v_add_u32 v10, s42, v10
    v_add_u32 v11, s42, v11
    s_waitcnt lgkmcnt(9)
    v_mfma_f32_32x32x16_bf16 v[16:31], v[52:55], v[108:111], v[16:31]
    ds_read_b128 v[68:71], v7 offset:16384
    ds_read_b64_tr_b16 v[124:125], v10
    ds_read_b64_tr_b16 v[126:127], v11
    v_add_u32 v10, s42, v10
    v_add_u32 v11, s42, v11
    s_waitcnt lgkmcnt(9)
    v_mfma_f32_32x32x16_bf16 v[16:31], v[56:59], v[112:115], v[16:31]
    ds_read_b128 v[72:75], v6 offset:20480
    ds_read_b64_tr_b16 v[128:129], v10
    ds_read_b64_tr_b16 v[130:131], v11
    v_add_u32 v10, s42, v10
    v_add_u32 v11, s42, v11
    s_waitcnt lgkmcnt(9)
    v_mfma_f32_32x32x16_bf16 v[16:31], v[60:63], v[116:119], v[16:31]
    ds_read_b128 v[76:79], v7 offset:20480
    ds_read_b64_tr_b16 v[132:133], v10
    ds_read_b64_tr_b16 v[134:135], v11
    v_add_u32 v10, s42, v10
    v_add_u32 v11, s42, v11
    s_waitcnt lgkmcnt(9)
    v_mfma_f32_32x32x16_bf16 v[16:31], v[64:67], v[120:123], v[16:31]
    ds_read_b128 v[80:83], v6 offset:24576
    ds_read_b64_tr_b16 v[136:137], v10
    ds_read_b64_tr_b16 v[138:139], v11
    v_add_u32 v10, s42, v10
    v_add_u32 v11, s42, v11
    s_waitcnt lgkmcnt(9)
    v_mfma_f32_32x32x16_bf16 v[16:31], v[68:71], v[124:127], v[16:31]
    ds_read_b128 v[84:87], v7 offset:24576
    ds_read_b64_tr_b16 v[140:141], v10
    ds_read_b64_tr_b16 v[142:143], v11
    s_waitcnt lgkmcnt(9)
    v_mfma_f32_32x32x16_bf16 v[16:31], v[72:75], v[128:131], v[16:31]
    s_waitcnt lgkmcnt(6)
    v_mfma_f32_32x32x16_bf16 v[16:31], v[76:79], v[132:135], v[16:31]
    s_waitcnt lgkmcnt(3)
    v_mfma_f32_32x32x16_bf16 v[16:31], v[80:83], v[136:139], v[16:31]
    s_waitcnt lgkmcnt(0)
    v_mfma_f32_32x32x16_bf16 v[16:31], v[84:87], v[140:143], v[16:31]
p0_kv_mm_done:
    v_mov_b32 v4, 163584
    v_mov_b32 v5, 1
    s_mov_b64 exec, 1
    ds_add_u32 v4, v5 offset:84
    s_mov_b64 exec, -1
    s_mul_i32 s3, s38, 12288
    s_add_u32 s3, s3, 143360
    v_add_u32 v12, s3, v1
    s_nop 7
    s_nop 0
    s_cmp_lg_u32 s15, 0
    s_cbranch_scc1 p0_kv_root
    s_cmp_eq_u32 s39, 0
    s_cbranch_scc1 p0_kv_root
    ds_write_b128 v12, v[16:19] offset:0
    ds_write_b128 v12, v[20:23] offset:1024
    ds_write_b128 v12, v[24:27] offset:2048
    ds_write_b128 v12, v[28:31] offset:3072
    s_waitcnt lgkmcnt(0)
    s_lshl_b32 s3, s38, 2
    v_mov_b32 v4, 163584
    v_add_u32 v4, s3, v4
    v_mov_b32 v5, 1
    s_mov_b64 exec, 1
    ds_add_u32 v4, v5 offset:32
    s_mov_b64 exec, -1
    s_branch p0_kv_none
p0_kv_root:
    s_lshl_b32 s3, s38, 2
    v_mov_b32 v4, 163584
    v_add_u32 v4, s3, v4
    s_cmp_lg_u32 s15, 0
    s_cbranch_scc1 p0_kvr_ok
p0_kvr:
    ds_read_b32 v5, v4 offset:32
    s_waitcnt lgkmcnt(0)
    v_readfirstlane_b32 s3, v5
    s_cmp_ge_u32 s3, 1
    s_cbranch_scc1 p0_kvr_ok
    s_sleep 1
    s_sub_u32 s18, s18, 1
    s_cbranch_scc0 p0_kvr
    s_mov_b32 s18, 0
p0_kvr_ok:
    ds_read_b128 v[32:35], v12 offset:0
    ds_read_b128 v[36:39], v12 offset:1024
    ds_read_b128 v[40:43], v12 offset:2048
    ds_read_b128 v[44:47], v12 offset:3072
    s_waitcnt lgkmcnt(0)
    v_add_f32 v16, v16, v32
    v_add_f32 v17, v17, v33
    v_add_f32 v18, v18, v34
    v_add_f32 v19, v19, v35
    v_add_f32 v20, v20, v36
    v_add_f32 v21, v21, v37
    v_add_f32 v22, v22, v38
    v_add_f32 v23, v23, v39
    v_add_f32 v24, v24, v40
    v_add_f32 v25, v25, v41
    v_add_f32 v26, v26, v42
    v_add_f32 v27, v27, v43
    v_add_f32 v28, v28, v44
    v_add_f32 v29, v29, v45
    v_add_f32 v30, v30, v46
    v_add_f32 v31, v31, v47
    s_lshl_b32 s43, s20, 1
    s_add_u32 s43, s43, s38
    s_cmp_eq_u32 s21, 2
    s_cbranch_scc1 p0_gate_epi
    v_cvt_pk_bf16_f32 v32, v16, v17
    v_cvt_pk_bf16_f32 v33, v18, v19
    v_cvt_pk_bf16_f32 v34, v20, v21
    v_cvt_pk_bf16_f32 v35, v22, v23
    v_cvt_pk_bf16_f32 v36, v24, v25
    v_cvt_pk_bf16_f32 v37, v26, v27
    v_cvt_pk_bf16_f32 v38, v28, v29
    v_cvt_pk_bf16_f32 v39, v30, v31
    s_lshl_b32 s44, s43, 12
    s_add_u32 s44, s44, 0
    s_cmp_eq_u32 s21, 1
    s_cbranch_scc1 p0_v_epi
    s_mov_b32 exec_lo, 0
    v_mov_b32 v38, 0x3f803f80
    v_mov_b32 v39, 0x00003f80
    s_mov_b32 exec_lo, -1
    buffer_store_dwordx4 v[32:35], v1, s[8:11], s44 offen sc1
    buffer_store_dwordx4 v[36:39], v1, s[8:11], s44 offen offset:1024 sc1
    s_branch p0_kv_arrive
p0_v_epi:
    v_max3_f32 v14, |v16|, |v17|, |v18|
    v_max3_f32 v14, v14, |v19|, |v20|
    v_max3_f32 v14, v14, |v21|, |v22|
    v_max3_f32 v14, v14, |v23|, |v24|
    v_max3_f32 v14, v14, |v25|, |v26|
    v_max3_f32 v14, v14, |v27|, |v28|
    v_max3_f32 v14, v14, |v29|, |v30|
    v_max_f32 v14, v14, |v31|
    v_and_b32 v13, 31, v0
    v_cmp_gt_u32 s[46:47], 28, v13
    v_cmp_lt_f32 vcc, 0x49800000, v14
    s_and_b64 vcc, vcc, s[46:47]
    s_cbranch_vccz p0_v_ok
    s_cmp_lg_u32 s15, 0
    s_cbranch_scc1 p0_v_ok
    s_mov_b32 s48, s96
    s_mov_b32 s49, s97
    s_mov_b32 s50, 0x100
    s_mov_b32 s51, 0x00020000
    v_mov_b32 v14, 1
    v_mov_b32 v15, 132
    s_mov_b64 exec, 1
    buffer_store_dword v14, v15, s[48:51], 0 offen sc1
    s_mov_b64 exec, -1
p0_v_ok:
    v_and_b32 v13, 31, v0
    v_cmp_eq_u32 vcc, 28, v13
    v_mov_b32 v14, 0x3f803f80
    s_nop 0
    v_cndmask_b32 v14, 0, v14, vcc
    v_cmp_lt_u32 vcc, 27, v13
    s_nop 1
    v_cndmask_b32 v32, v32, v14, vcc
    v_cndmask_b32 v33, v33, v14, vcc
    v_cndmask_b32 v34, v34, v14, vcc
    v_cndmask_b32 v35, v35, v14, vcc
    v_cndmask_b32 v36, v36, v14, vcc
    v_cndmask_b32 v37, v37, v14, vcc
    v_cndmask_b32 v38, v38, v14, vcc
    v_cndmask_b32 v39, v39, v14, vcc
    buffer_store_dwordx4 v[32:35], v1, s[8:11], s44 offen offset:2048 sc1
    buffer_store_dwordx4 v[36:39], v1, s[8:11], s44 offen offset:3072 sc1
    s_branch p0_kv_arrive
p0_gate_epi:
    s_mov_b32 s42, 0x3fb8aa3b
    v_mul_f32 v16, s42, v16
    v_mul_f32 v17, s42, v17
    v_mul_f32 v18, s42, v18
    v_mul_f32 v19, s42, v19
    v_mul_f32 v20, s42, v20
    v_mul_f32 v21, s42, v21
    v_mul_f32 v22, s42, v22
    v_mul_f32 v23, s42, v23
    v_mul_f32 v24, s42, v24
    v_mul_f32 v25, s42, v25
    v_mul_f32 v26, s42, v26
    v_mul_f32 v27, s42, v27
    v_mul_f32 v28, s42, v28
    v_mul_f32 v29, s42, v29
    v_mul_f32 v30, s42, v30
    v_mul_f32 v31, s42, v31
    v_exp_f32 v16, -v16
    v_exp_f32 v17, -v17
    v_exp_f32 v18, -v18
    v_exp_f32 v19, -v19
    v_exp_f32 v20, -v20
    v_exp_f32 v21, -v21
    v_exp_f32 v22, -v22
    v_exp_f32 v23, -v23
    v_exp_f32 v24, -v24
    v_exp_f32 v25, -v25
    v_exp_f32 v26, -v26
    v_exp_f32 v27, -v27
    v_exp_f32 v28, -v28
    v_exp_f32 v29, -v29
    v_exp_f32 v30, -v30
    v_exp_f32 v31, -v31
    v_add_f32 v16, 1.0, v16
    v_add_f32 v17, 1.0, v17
    v_add_f32 v18, 1.0, v18
    v_add_f32 v19, 1.0, v19
    v_add_f32 v20, 1.0, v20
    v_add_f32 v21, 1.0, v21
    v_add_f32 v22, 1.0, v22
    v_add_f32 v23, 1.0, v23
    v_add_f32 v24, 1.0, v24
    v_add_f32 v25, 1.0, v25
    v_add_f32 v26, 1.0, v26
    v_add_f32 v27, 1.0, v27
    v_add_f32 v28, 1.0, v28
    v_add_f32 v29, 1.0, v29
    v_add_f32 v30, 1.0, v30
    v_add_f32 v31, 1.0, v31
    v_rcp_f32 v16, v16
    v_rcp_f32 v17, v17
    v_rcp_f32 v18, v18
    v_rcp_f32 v19, v19
    v_rcp_f32 v20, v20
    v_rcp_f32 v21, v21
    v_rcp_f32 v22, v22
    v_rcp_f32 v23, v23
    v_rcp_f32 v24, v24
    v_rcp_f32 v25, v25
    v_rcp_f32 v26, v26
    v_rcp_f32 v27, v27
    v_rcp_f32 v28, v28
    v_rcp_f32 v29, v29
    v_rcp_f32 v30, v30
    v_rcp_f32 v31, v31
    v_lshrrev_b32 v13, 5, v0
    v_lshlrev_b32 v13, 6, v13
    s_lshl_b32 s44, s43, 7
    s_add_u32 s44, s44, 262144
    v_and_b32 v14, 31, v0
    v_cmp_eq_u32 vcc, 0, v14
    s_and_saveexec_b64 s[46:47], vcc
    buffer_store_dwordx4 v[16:19], v13, s[8:11], s44 offen offset:0 sc1
    buffer_store_dwordx4 v[20:23], v13, s[8:11], s44 offen offset:16 sc1
    buffer_store_dwordx4 v[24:27], v13, s[8:11], s44 offen offset:32 sc1
    buffer_store_dwordx4 v[28:31], v13, s[8:11], s44 offen offset:48 sc1
    s_mov_b64 exec, -1
p0_kv_arrive:
    s_cmp_eq_u32 s15, 0
    s_cbranch_scc1 p0_kv_real
    s_mov_b32 s15, 0
    s_branch p0_kv_setup
p0_kv_real:
    s_mov_b32 s16, 1
    s_branch p0_kv_b0
p0_kv_nojob:
    v_mov_b32 v4, 163584
    v_mov_b32 v5, 1
    s_mov_b64 exec, 1
    ds_add_u32 v4, v5 offset:84
    s_mov_b64 exec, -1
p0_kv_none:
    s_mov_b32 s16, 0
p0_kv_b0:
    s_setprio 0
    s_cmp_eq_u32 s16, 0
    s_cbranch_scc1 p1_noarr
    v_mov_b32 v14, 163584
    v_mov_b32 v15, 1
    s_waitcnt vmcnt(0)
    s_mov_b64 exec, 1
    s_or_b32 s3, s20, s21
    s_cmp_eq_u32 s22, 4
    s_cselect_b32 s3, s3, 1
    s_cmp_eq_u32 s3, 0
    s_cbranch_scc0 p1_nok0
    s_mov_b32 s48, s96
    s_mov_b32 s49, s97
    s_mov_b32 s50, 0x100
    s_mov_b32 s51, 0x00020000
    v_mov_b32 v12, 1
    v_mov_b32 v13, 136
    buffer_store_dword v12, v13, s[48:51], 0 offen sc1
p1_nok0:
    ds_add_rtn_u32 v15, v14, v15 offset:40
    s_waitcnt lgkmcnt(0)
    v_readfirstlane_b32 s3, v15
    s_cmp_eq_u32 s3, 1
    s_cbranch_scc0 p1_arrdone
    s_mov_b32 s48, s96
    s_mov_b32 s49, s97
    s_mov_b32 s50, 0x100
    s_mov_b32 s51, 0x00020000
    v_mov_b32 v14, 1
    s_cmp_eq_u32 s21, 2
    s_cselect_b32 s3, 64, 0
    v_mov_b32 v15, s3
    buffer_atomic_add v14, v15, s[48:51], 0 offen sc0 sc1
    s_waitcnt vmcnt(0)
    v_readfirstlane_b32 s3, v14
    s_cmp_eq_u32 s21, 2
    s_cselect_b32 s46, 31, 63
    s_mov_b32 s47, 128
    s_cselect_b32 s47, 144, s47
    s_cmp_eq_u32 s3, s46
    s_cbranch_scc0 p1_arrdone
    v_mov_b32 v14, 1
    v_mov_b32 v15, s47
    buffer_store_dword v14, v15, s[48:51], 0 offen sc1
p1_arrdone:
    s_mov_b64 exec, -1
p1_noarr:
    s_branch p1_att
p0_bgw:
    s_cmp_eq_u32 s22, 8
    s_cbranch_scc0 p0_t9
    s_mov_b32 s48, s64
    s_mov_b32 s49, s65
    s_mov_b32 s50, 0x1c0000
    s_mov_b32 s51, 0x00020000
    s_and_b32 s3, s2, 7
    s_mul_i32 s3, s3, 229376
    s_lshr_b32 s46, s2, 3
    s_mul_i32 s46, s46, 7168
    s_add_u32 s3, s3, s46
    v_lshlrev_b32 v50, 7, v0
    s_mov_b32 exec_hi, 0xffffff
    buffer_load_dword v52, v50, s[48:51], s3 offen
    s_mov_b64 exec, -1
    s_branch p0_t_done
p0_t9:
    s_cmp_eq_u32 s22, 9
    s_cbranch_scc0 p0_t10
    s_mov_b32 s48, s66
    s_mov_b32 s49, s67
    s_mov_b32 s50, 0x62000
    s_mov_b32 s51, 0x00020000
    s_lshr_b32 s3, s2, 3
    s_mul_i32 s3, s3, 12544
    v_lshlrev_b32 v50, 7, v0
    s_mov_b32 m0, 161792
    s_nop 0
    buffer_load_dword v50, s[48:51], s3 offen lds
    s_add_u32 s3, s3, 8192
    s_mov_b32 exec_hi, 3
    buffer_load_dword v50, s[48:51], s3 offen lds
    s_mov_b64 exec, -1
    s_branch p0_t_done
p0_t10:
    s_cmp_eq_u32 s22, 10
    s_cbranch_scc0 p0_t_done
    s_lshr_b32 s3, s2, 3
    s_mul_i32 s3, s3, 896
    v_lshlrev_b32 v50, 7, v0
    s_mov_b64 exec, 0x7f
    s_mov_b32 s48, s68
    s_mov_b32 s49, s69
    s_mov_b32 s50, 0x6200
    s_mov_b32 s51, 0x00020000
    buffer_load_dword v52, v50, s[48:51], s3 offen
    s_mov_b32 s48, s70
    s_mov_b32 s49, s71
    s_mov_b32 s50, 0x6200
    s_mov_b32 s51, 0x00020000
    buffer_load_dword v53, v50, s[48:51], s3 offen
    s_mov_b64 exec, -1
p0_t_done:
    s_cmp_eq_u32 s22, 11
    s_cbranch_scc0 p0_nononce
    s_cmp_eq_u32 s2, 0
    s_cbranch_scc0 p0_nononce
    s_mov_b32 s48, s96
    s_mov_b32 s49, s97
    s_mov_b32 s50, 0x100
    s_mov_b32 s51, 0x00020000
    v_mov_b32 v7, 0
    s_memrealtime s[60:61]
    s_waitcnt lgkmcnt(0)
    s_and_b32 s60, s60, 0xfffffffc
    s_or_b32 s60, s60, 1
    v_mov_b32 v6, s60
    s_mov_b64 exec, 1
    buffer_store_dword v6, v7, s[48:51], 0 offen offset:140 sc1
    s_mov_b64 exec, -1
p0_nononce:
    s_cmp_eq_u32 s21, 2
    s_cbranch_scc0 p0_wkv_done
    s_cmp_eq_u32 s22, 8
    s_cbranch_scc0 p0_wkv_done
    s_mov_b32 s28, s92
    s_mov_b32 s29, s93
    s_mov_b32 s30, 0x380
    s_mov_b32 s31, 0x00020000
    v_lshlrev_b32 v3, 1, v0
    buffer_load_ushort v10, v3, s[28:31], 0 offen offset:0
    buffer_load_ushort v11, v3, s[28:31], 0 offen offset:128
    buffer_load_ushort v12, v3, s[28:31], 0 offen offset:256
    buffer_load_ushort v13, v3, s[28:31], 0 offen offset:384
    buffer_load_ushort v14, v3, s[28:31], 0 offen offset:512
    buffer_load_ushort v15, v3, s[28:31], 0 offen offset:640
    buffer_load_ushort v16, v3, s[28:31], 0 offen offset:768
    v_lshlrev_b32 v4, 3, v0
    v_add_u32 v4, 114688, v4
    s_waitcnt vmcnt(0)
    v_lshl_or_b32 v20, v10, 16, v10
    v_mov_b32 v21, v20
    ds_write_b64 v4, v[20:21] offset:0
    v_lshl_or_b32 v22, v11, 16, v11
    v_mov_b32 v23, v22
    ds_write_b64 v4, v[22:23] offset:512
    v_lshl_or_b32 v24, v12, 16, v12
    v_mov_b32 v25, v24
    ds_write_b64 v4, v[24:25] offset:1024
    v_lshl_or_b32 v26, v13, 16, v13
    v_mov_b32 v27, v26
    ds_write_b64 v4, v[26:27] offset:1536
    v_lshl_or_b32 v28, v14, 16, v14
    v_mov_b32 v29, v28
    ds_write_b64 v4, v[28:29] offset:2048
    v_lshl_or_b32 v30, v15, 16, v15
    v_mov_b32 v31, v30
    ds_write_b64 v4, v[30:31] offset:2560
    v_lshl_or_b32 v32, v16, 16, v16
    v_mov_b32 v33, v32
    ds_write_b64 v4, v[32:33] offset:3072
p0_wkv_done:
    s_lshl_b32 s37, s21, 1
    s_and_b32 s3, s23, 1
    s_add_u32 s37, s37, s3
    v_and_b32 v4, 31, v0
    s_lshl_b32 s3, s37, 6
    v_lshl_add_u32 v4, v4, 1, s3
    s_mov_b32 s40, s76
    s_mov_b32 s41, s77
    s_mov_b32 s42, 0x380
    s_mov_b32 s43, 0x00020000
    buffer_load_ushort v8, v4, s[40:43], 0 offen
    s_mov_b32 s44, s78
    s_mov_b32 s45, s79
    s_mov_b32 s46, 0x380
    s_mov_b32 s47, 0x00020000
    buffer_load_ushort v9, v4, s[44:47], 0 offen
    s_mov_b32 s52, s88
    s_mov_b32 s53, s89
    s_mov_b32 s54, 0x380
    s_mov_b32 s55, 0x00020000
    buffer_load_ushort v10, v4, s[52:55], 0 offen
    s_barrier
    s_waitcnt vmcnt(3) lgkmcnt(0)
    v_mov_b32 v4, 163584
    v_mov_b32 v5, 1
    s_mov_b64 exec, 1
    ds_add_u32 v4, v5 offset:28
    s_mov_b64 exec, -1
    s_branch p1_bg
p1_att:
    v_mov_b32 v4, 163584
p1_qd:
    ds_read_b32 v5, v4 offset:96
    s_waitcnt lgkmcnt(0)
    v_readfirstlane_b32 s3, v5
    s_cmp_ge_u32 s3, 4
    s_cbranch_scc1 p1_qd_ok
    s_sleep 2
    s_sub_u32 s18, s18, 1
    s_cbranch_scc0 p1_qd
    s_mov_b32 s18, 0
p1_qd_ok:
    v_add_u32 v2, 147456, v1
    ds_read_b128 v[8:11], v2 offset:0
    ds_read_b128 v[12:15], v2 offset:1024
    ds_read_b128 v[16:19], v2 offset:2048
    ds_read_b128 v[20:23], v2 offset:3072
    ds_read_b128 v[24:27], v2 offset:4096
    ds_read_b128 v[28:31], v2 offset:5120
    ds_read_b128 v[32:35], v2 offset:6144
    ds_read_b128 v[36:39], v2 offset:7168
    s_add_u32 s28, s24, 0
    s_addc_u32 s29, s25, 0
    s_mov_b32 s31, 0x00020000
    s_mov_b32 s44, 0
    s_mov_b32 s51, 0
    s_cmp_lt_u32 s22, 4
    s_cselect_b32 s53, 1, -1
    s_cmp_eq_u32 s22, 7
    s_cbranch_scc0 att_nosel
    v_lshrrev_b32 v104, 4, v1
    v_and_b32 v105, 31, v104
    v_lshrrev_b32 v104, 5, v104
    v_lshlrev_b32 v104, 2, v104
    v_sub_u32 v105, v105, v104
    v_cmp_eq_u32 vcc, 0, v105
    v_mov_b32 v106, 0x3f80
    s_nop 0
    v_cndmask_b32 v108, 0, v106, vcc
    v_cmp_eq_u32 vcc, 1, v105
    v_mov_b32 v106, 0x3f800000
    s_nop 0
    v_cndmask_b32 v107, 0, v106, vcc
    v_or_b32 v108, v108, v107
    v_cmp_eq_u32 vcc, 2, v105
    v_mov_b32 v106, 0x3f80
    s_nop 0
    v_cndmask_b32 v109, 0, v106, vcc
    v_cmp_eq_u32 vcc, 3, v105
    v_mov_b32 v106, 0x3f800000
    s_nop 0
    v_cndmask_b32 v107, 0, v106, vcc
    v_or_b32 v109, v109, v107
    v_cmp_eq_u32 vcc, 8, v105
    v_mov_b32 v106, 0x3f80
    s_nop 0
    v_cndmask_b32 v110, 0, v106, vcc
    v_cmp_eq_u32 vcc, 9, v105
    v_mov_b32 v106, 0x3f800000
    s_nop 0
    v_cndmask_b32 v107, 0, v106, vcc
    v_or_b32 v110, v110, v107
    v_cmp_eq_u32 vcc, 10, v105
    v_mov_b32 v106, 0x3f80
    s_nop 0
    v_cndmask_b32 v111, 0, v106, vcc
    v_cmp_eq_u32 vcc, 11, v105
    v_mov_b32 v106, 0x3f800000
    s_nop 0
    v_cndmask_b32 v107, 0, v106, vcc
    v_or_b32 v111, v111, v107
    v_add_u32 v104, 162560, v1
    ds_write_b128 v104, v[108:111]
att_nosel:
    s_mov_b32 s56, s96
    s_mov_b32 s57, s97
    s_mov_b32 s58, 0x100
    s_mov_b32 s59, 0x00020000
    s_cmp_eq_u32 s22, 0
    s_cbranch_scc0 att_nopollA
    v_mov_b32 v2, 136
att_pollA:
    buffer_load_dword v104, v2, s[56:59], 0 offen sc1
    s_waitcnt vmcnt(0)
    v_readfirstlane_b32 s3, v104
    s_cmp_lg_u32 s3, 0
    s_cbranch_scc1 att_nopollA
    s_sleep 8
    s_sub_u32 s18, s18, 1
    s_cbranch_scc0 att_pollA
    s_mov_b32 s18, 0
att_nopollA:
    v_mov_b32 v3, 163584
    s_add_u32 s44, s44, 8
    v_mov_b32 v2, 1
    s_waitcnt lgkmcnt(0)
    s_mov_b64 exec, 1
    ds_add_u32 v3, v2 offset:0
    s_mov_b64 exec, -1
att_ba:
    ds_read_b32 v2, v3 offset:0
    s_waitcnt lgkmcnt(0)
    v_readfirstlane_b32 s3, v2
    s_cmp_ge_u32 s3, s44
    s_cbranch_scc1 att_ba_ok
    s_sleep 1
    s_sub_u32 s18, s18, 1
    s_cbranch_scc0 att_ba
    s_mov_b32 s18, 0
att_ba_ok:
    s_mov_b32 s30, 0x40000
    s_cmp_ge_u32 s22, 4
    s_cbranch_scc1 att_shhi
    buffer_load_dwordx4 v[120:123], v1, s[28:31], 0 offen sc1
    buffer_load_dwordx4 v[124:127], v1, s[28:31], 0 offen offset:1024 sc1
    s_lshl_b32 s3, s22, 11
    s_add_u32 s3, s3, 147456
    v_add_u32 v2, s3, v1
    ds_read_b128 v[40:43], v2
    ds_read_b128 v[44:47], v2 offset:1024
    s_waitcnt vmcnt(0) lgkmcnt(0)
    v_mfma_f32_32x32x16_bf16 v[56:71], v[120:123], v[40:43], 0
    v_mfma_f32_32x32x16_bf16 v[56:71], v[124:127], v[44:47], v[56:71]
    s_lshl_b32 s3, s22, 7
    s_add_u32 s3, s3, 162048
    v_lshrrev_b32 v3, 2, v1
    v_and_b32 v3, 127, v3
    v_add_u32 v3, s3, v3
    s_nop 7
    v_max3_f32 v2, v56, v57, v58
    v_max3_f32 v2, v2, v59, v60
    v_max3_f32 v2, v2, v61, v62
    v_max3_f32 v2, v2, v63, v64
    v_max3_f32 v2, v2, v65, v66
    v_max3_f32 v2, v2, v67, v68
    v_max3_f32 v2, v2, v69, v70
    v_max_f32 v2, v2, v71
    v_mov_b32 v40, v2
    s_nop 1
    v_permlane32_swap_b32 v2, v40
    v_max_f32 v2, v2, v40
    v_cvt_pk_bf16_f32 v2, -v2, 0
    s_mov_b32 exec_hi, 0
    ds_write_b32 v3, v2
    s_mov_b64 exec, -1
    s_branch att_shwait
att_shhi:
    s_cmp_eq_u32 s22, 7
    s_cbranch_scc0 att_shwait
    v_mov_b32 v2, 128
att_pollm:
    buffer_load_dwordx2 v[104:105], v2, s[56:59], 0 offen sc1
    s_waitcnt vmcnt(0)
    v_readfirstlane_b32 s3, v104
    s_cmp_lg_u32 s3, 0
    s_cbranch_scc1 att_pollmok
    s_sleep 8
    s_sub_u32 s18, s18, 1
    s_cbranch_scc0 att_pollm
    s_mov_b32 s18, 0
att_pollmok:
    v_mov_b32 v3, 163584
    s_mov_b64 exec, 1
    ds_add_u32 v3, v105 offset:12
    s_mov_b64 exec, -1
att_shwait:
    v_mov_b32 v3, 163584
    s_add_u32 s44, s44, 8
    v_mov_b32 v2, 1
    s_waitcnt lgkmcnt(0)
    s_mov_b64 exec, 1
    ds_add_u32 v3, v2 offset:0
    s_mov_b64 exec, -1
att_bs:
    ds_read_b32 v2, v3 offset:0
    s_waitcnt lgkmcnt(0)
    v_readfirstlane_b32 s3, v2
    s_cmp_ge_u32 s3, s44
    s_cbranch_scc1 att_bs_ok
    s_sleep 1
    s_sub_u32 s18, s18, 1
    s_cbranch_scc0 att_bs
    s_mov_b32 s18, 0
att_bs_ok:
    v_lshrrev_b32 v3, 2, v1
    v_and_b32 v3, 127, v3
    v_add_u32 v3, 162048, v3
    ds_read_b32 v40, v3 offset:0
    ds_read_b32 v41, v3 offset:128
    ds_read_b32 v42, v3 offset:256
    ds_read_b32 v43, v3 offset:384
    s_waitcnt lgkmcnt(0)
    s_mov_b32 exec_lo, 0
    v_mov_b32 v14, v40
    v_mov_b32 v22, v41
    v_mov_b32 v30, v42
    v_mov_b32 v38, v43
    s_mov_b32 exec_lo, -1
    s_lshr_b32 s52, s2, 3
    s_lshl_b32 s52, s52, 3
    s_add_u32 s52, s52, s22
    s_lshl_b32 s52, s52, 10
att_restart:
    s_mov_b32 s30, 0x40000
    s_lshl_b32 s43, s22, 15
    buffer_load_dwordx4 v[136:139], v1, s[28:31], s43 offen sc1
    buffer_load_dwordx4 v[140:143], v1, s[28:31], s43 offen offset:1024 sc1
    buffer_load_dwordx4 v[152:155], v1, s[28:31], s43 offen offset:2048 sc1
    buffer_load_dwordx4 v[156:159], v1, s[28:31], s43 offen offset:3072 sc1
    s_add_u32 s43, s43, 4096
    buffer_load_dwordx4 v[144:147], v1, s[28:31], s43 offen sc1
    buffer_load_dwordx4 v[148:151], v1, s[28:31], s43 offen offset:1024 sc1
    s_lshl_b32 s3, s22, 9
    s_mov_b32 m0, 161792
    v_lshlrev_b32 v2, 3, v1
    s_mov_b64 exec, 0xff
    buffer_load_dword v2, s[28:31], s52 offen sc1 lds
    s_mov_b64 exec, -1
    v_mov_b32 v4, 0
    v_mov_b32 v5, 0
    v_mov_b32 v6, 0
    v_mov_b32 v7, 0
    v_mov_b32 v160, 0
    v_mov_b32 v161, 0
    v_mov_b32 v162, 0
    v_mov_b32 v163, 0
    v_mov_b32 v164, 0
    v_mov_b32 v165, 0
    v_mov_b32 v166, 0
    v_mov_b32 v167, 0
att_haveshift:
    v_mov_b32 v120, 0
    v_mov_b32 v121, 0
    v_mov_b32 v122, 0
    v_mov_b32 v123, 0
    v_mov_b32 v132, 0
    v_mov_b32 v133, 0
    v_mov_b32 v134, 0
    v_mov_b32 v135, 0
    s_and_b32 s3, s22, 3
    s_lshl_b32 s3, s3, 2
    s_add_u32 s3, s3, 163648
    v_mov_b32 v2, s3
    v_mfma_f32_32x32x16_bf16 v[40:55], v[160:163], v[4:7], 0
    v_mfma_f32_32x32x16_bf16 v[56:71], v[160:163], v[4:7], 0
    v_mfma_f32_32x32x16_bf16 v[72:87], v[160:163], v[4:7], 0
    v_mfma_f32_32x32x16_bf16 v[88:103], v[160:163], v[4:7], 0
    s_waitcnt vmcnt(5)
    v_mfma_f32_32x32x16_bf16 v[104:119], v[136:139], v[8:11], 0
    v_mfma_f32_32x32x16_bf16 v[104:119], v[140:143], v[12:15], v[104:119]
    s_mov_b32 s48, 0
    s_setprio 2
    s_nop 7
    s_nop 1
.p2align 3
att_loop:
    v_mfma_f32_32x32x16_bf16 v[88:103], v[160:163], v[120:123], v[88:103]
    v_exp_f32 v104, v104
    v_mov_b32 v3, s53
    v_exp_f32 v105, v105
    v_exp_f32 v106, v106
    s_mov_b64 exec, 1
    ds_add_rtn_u32 v3, v2, v3
    s_mov_b64 exec, -1
    v_exp_f32 v107, v107
    v_cvt_pk_bf16_f32 v6, v132, v133
    v_cvt_pk_bf16_f32 v7, v134, v135
    v_mfma_f32_32x32x16_bf16 v[120:135], v[136:139], v[16:19], 0
    v_exp_f32 v108, v108
    v_exp_f32 v109, v109
    v_exp_f32 v110, v110
    v_exp_f32 v111, v111
    v_cvt_pk_bf16_f32 v104, v104, v105
    v_cvt_pk_bf16_f32 v105, v106, v107
    v_mfma_f32_32x32x16_bf16 v[120:135], v[140:143], v[20:23], v[120:135]
    v_exp_f32 v112, v112
    v_exp_f32 v113, v113
    v_exp_f32 v114, v114
    v_exp_f32 v115, v115
    v_cvt_pk_bf16_f32 v106, v108, v109
    v_cvt_pk_bf16_f32 v107, v110, v111
    v_mfma_f32_32x32x16_bf16 v[88:103], v[164:167], v[4:7], v[88:103]
    v_exp_f32 v116, v116
    v_exp_f32 v117, v117
    v_exp_f32 v118, v118
    v_exp_f32 v119, v119
    v_cvt_pk_bf16_f32 v4, v112, v113
    v_cvt_pk_bf16_f32 v5, v114, v115
    s_waitcnt vmcnt(2)
    v_mfma_f32_32x32x16_bf16 v[40:55], v[152:155], v[104:107], v[40:55]
    v_exp_f32 v120, v120
    buffer_load_dwordx4 v[160:163], v1, s[28:31], s43 offen offset:2048 sc1
    v_exp_f32 v121, v121
    buffer_load_dwordx4 v[164:167], v1, s[28:31], s43 offen offset:3072 sc1
    v_exp_f32 v122, v122
    s_add_u32 s43, s43, 4096
    v_exp_f32 v123, v123
    s_cmp_eq_u32 s48, 3
    v_cvt_pk_bf16_f32 v6, v116, v117
    v_cvt_pk_bf16_f32 v7, v118, v119
    v_mfma_f32_32x32x16_bf16 v[104:119], v[136:139], v[24:27], 0
    v_exp_f32 v124, v124
    s_cselect_b32 s30, 0, s30
    v_exp_f32 v125, v125
    v_exp_f32 v126, v126
    v_exp_f32 v127, v127
    v_cvt_pk_bf16_f32 v120, v120, v121
    v_cvt_pk_bf16_f32 v121, v122, v123
    v_mfma_f32_32x32x16_bf16 v[104:119], v[140:143], v[28:31], v[104:119]
    v_exp_f32 v128, v128
    v_exp_f32 v129, v129
    v_exp_f32 v130, v130
    v_exp_f32 v131, v131
    v_cvt_pk_bf16_f32 v122, v124, v125
    v_cvt_pk_bf16_f32 v123, v126, v127
    v_mfma_f32_32x32x16_bf16 v[40:55], v[156:159], v[4:7], v[40:55]
    v_exp_f32 v132, v132
    v_exp_f32 v133, v133
    v_exp_f32 v134, v134
    v_exp_f32 v135, v135
    v_cvt_pk_bf16_f32 v4, v128, v129
    v_cvt_pk_bf16_f32 v5, v130, v131
    v_mfma_f32_32x32x16_bf16 v[56:71], v[152:155], v[120:123], v[56:71]
    v_exp_f32 v104, v104
    s_waitcnt lgkmcnt(0)
    v_exp_f32 v105, v105
    v_readfirstlane_b32 s54, v3
    v_exp_f32 v106, v106
    v_exp_f32 v107, v107
    s_mul_i32 s54, s54, s53
    v_cvt_pk_bf16_f32 v6, v132, v133
    v_cvt_pk_bf16_f32 v7, v134, v135
    v_mfma_f32_32x32x16_bf16 v[120:135], v[136:139], v[32:35], 0
    v_exp_f32 v108, v108
    s_cmp_gt_i32 s54, 0
    v_exp_f32 v109, v109
    s_cbranch_scc1 att_fp2a
    s_setprio 2
    s_branch att_fp2b
att_fp2a:
    s_setprio 1
att_fp2b:
    v_exp_f32 v110, v110
    v_exp_f32 v111, v111
    v_cvt_pk_bf16_f32 v104, v104, v105
    v_cvt_pk_bf16_f32 v105, v106, v107
    v_mfma_f32_32x32x16_bf16 v[120:135], v[140:143], v[36:39], v[120:135]
    v_exp_f32 v112, v112
    v_exp_f32 v113, v113
    v_exp_f32 v114, v114
    v_exp_f32 v115, v115
    v_cvt_pk_bf16_f32 v106, v108, v109
    v_cvt_pk_bf16_f32 v107, v110, v111
    v_mfma_f32_32x32x16_bf16 v[56:71], v[156:159], v[4:7], v[56:71]
    v_exp_f32 v116, v116
    v_exp_f32 v117, v117
    v_exp_f32 v118, v118
    v_exp_f32 v119, v119
    v_cvt_pk_bf16_f32 v4, v112, v113
    v_cvt_pk_bf16_f32 v5, v114, v115
    v_mfma_f32_32x32x16_bf16 v[72:87], v[152:155], v[104:107], v[72:87]
    v_exp_f32 v120, v120
    v_exp_f32 v121, v121
    v_exp_f32 v122, v122
    v_exp_f32 v123, v123
    s_waitcnt vmcnt(2)
    v_cvt_pk_bf16_f32 v6, v116, v117
    v_cvt_pk_bf16_f32 v7, v118, v119
    v_mfma_f32_32x32x16_bf16 v[104:119], v[144:147], v[8:11], 0
    v_exp_f32 v124, v124
    buffer_load_dwordx4 v[136:139], v1, s[28:31], s43 offen sc1
    v_exp_f32 v125, v125
    buffer_load_dwordx4 v[140:143], v1, s[28:31], s43 offen offset:1024 sc1
    v_exp_f32 v126, v126
    v_exp_f32 v127, v127
    v_cvt_pk_bf16_f32 v120, v120, v121
    v_cvt_pk_bf16_f32 v121, v122, v123
    v_mfma_f32_32x32x16_bf16 v[104:119], v[148:151], v[12:15], v[104:119]
    v_exp_f32 v128, v128
    v_exp_f32 v129, v129
    v_exp_f32 v130, v130
    v_exp_f32 v131, v131
    v_cvt_pk_bf16_f32 v122, v124, v125
    v_cvt_pk_bf16_f32 v123, v126, v127
    v_mfma_f32_32x32x16_bf16 v[72:87], v[156:159], v[4:7], v[72:87]
    v_exp_f32 v132, v132
    v_exp_f32 v133, v133
    v_exp_f32 v134, v134
    v_exp_f32 v135, v135
    v_cvt_pk_bf16_f32 v4, v128, v129
    v_cvt_pk_bf16_f32 v5, v130, v131
    v_mfma_f32_32x32x16_bf16 v[88:103], v[152:155], v[120:123], v[88:103]
    v_exp_f32 v104, v104
    v_mov_b32 v3, s53
    v_exp_f32 v105, v105
    v_exp_f32 v106, v106
    s_mov_b64 exec, 1
    ds_add_rtn_u32 v3, v2, v3
    s_mov_b64 exec, -1
    v_exp_f32 v107, v107
    v_cvt_pk_bf16_f32 v6, v132, v133
    v_cvt_pk_bf16_f32 v7, v134, v135
    v_mfma_f32_32x32x16_bf16 v[120:135], v[144:147], v[16:19], 0
    v_exp_f32 v108, v108
    v_exp_f32 v109, v109
    v_exp_f32 v110, v110
    v_exp_f32 v111, v111
    v_cvt_pk_bf16_f32 v104, v104, v105
    v_cvt_pk_bf16_f32 v105, v106, v107
    v_mfma_f32_32x32x16_bf16 v[120:135], v[148:151], v[20:23], v[120:135]
    v_exp_f32 v112, v112
    v_exp_f32 v113, v113
    v_exp_f32 v114, v114
    v_exp_f32 v115, v115
    v_cvt_pk_bf16_f32 v106, v108, v109
    v_cvt_pk_bf16_f32 v107, v110, v111
    v_mfma_f32_32x32x16_bf16 v[88:103], v[156:159], v[4:7], v[88:103]
    v_exp_f32 v116, v116
    v_exp_f32 v117, v117
    v_exp_f32 v118, v118
    v_exp_f32 v119, v119
    v_cvt_pk_bf16_f32 v4, v112, v113
    v_cvt_pk_bf16_f32 v5, v114, v115
    s_waitcnt vmcnt(2)
    v_mfma_f32_32x32x16_bf16 v[40:55], v[160:163], v[104:107], v[40:55]
    v_exp_f32 v120, v120
    buffer_load_dwordx4 v[152:155], v1, s[28:31], s43 offen offset:2048 sc1
    v_exp_f32 v121, v121
    buffer_load_dwordx4 v[156:159], v1, s[28:31], s43 offen offset:3072 sc1
    v_exp_f32 v122, v122
    s_add_u32 s43, s43, 4096
    v_exp_f32 v123, v123
    v_cvt_pk_bf16_f32 v6, v116, v117
    v_cvt_pk_bf16_f32 v7, v118, v119
    v_mfma_f32_32x32x16_bf16 v[104:119], v[144:147], v[24:27], 0
    v_exp_f32 v124, v124
    v_exp_f32 v125, v125
    v_exp_f32 v126, v126
    v_exp_f32 v127, v127
    v_cvt_pk_bf16_f32 v120, v120, v121
    v_cvt_pk_bf16_f32 v121, v122, v123
    v_mfma_f32_32x32x16_bf16 v[104:119], v[148:151], v[28:31], v[104:119]
    v_exp_f32 v128, v128
    v_exp_f32 v129, v129
    v_exp_f32 v130, v130
    v_exp_f32 v131, v131
    v_cvt_pk_bf16_f32 v122, v124, v125
    v_cvt_pk_bf16_f32 v123, v126, v127
    v_mfma_f32_32x32x16_bf16 v[40:55], v[164:167], v[4:7], v[40:55]
    v_exp_f32 v132, v132
    v_exp_f32 v133, v133
    v_exp_f32 v134, v134
    v_exp_f32 v135, v135
    v_cvt_pk_bf16_f32 v4, v128, v129
    v_cvt_pk_bf16_f32 v5, v130, v131
    v_mfma_f32_32x32x16_bf16 v[56:71], v[160:163], v[120:123], v[56:71]
    v_exp_f32 v104, v104
    s_waitcnt lgkmcnt(0)
    v_exp_f32 v105, v105
    v_readfirstlane_b32 s54, v3
    v_exp_f32 v106, v106
    v_exp_f32 v107, v107
    s_mul_i32 s54, s54, s53
    v_cvt_pk_bf16_f32 v6, v132, v133
    v_cvt_pk_bf16_f32 v7, v134, v135
    v_mfma_f32_32x32x16_bf16 v[120:135], v[144:147], v[32:35], 0
    v_exp_f32 v108, v108
    s_cmp_gt_i32 s54, 0
    v_exp_f32 v109, v109
    s_cbranch_scc1 att_fp6a
    s_setprio 2
    s_branch att_fp6b
att_fp6a:
    s_setprio 1
att_fp6b:
    v_exp_f32 v110, v110
    v_exp_f32 v111, v111
    v_cvt_pk_bf16_f32 v104, v104, v105
    v_cvt_pk_bf16_f32 v105, v106, v107
    v_mfma_f32_32x32x16_bf16 v[120:135], v[148:151], v[36:39], v[120:135]
    v_exp_f32 v112, v112
    v_exp_f32 v113, v113
    v_exp_f32 v114, v114
    v_exp_f32 v115, v115
    v_cvt_pk_bf16_f32 v106, v108, v109
    v_cvt_pk_bf16_f32 v107, v110, v111
    v_mfma_f32_32x32x16_bf16 v[56:71], v[164:167], v[4:7], v[56:71]
    v_exp_f32 v116, v116
    v_exp_f32 v117, v117
    v_exp_f32 v118, v118
    v_exp_f32 v119, v119
    v_cvt_pk_bf16_f32 v4, v112, v113
    v_cvt_pk_bf16_f32 v5, v114, v115
    v_mfma_f32_32x32x16_bf16 v[72:87], v[160:163], v[104:107], v[72:87]
    v_exp_f32 v120, v120
    v_exp_f32 v121, v121
    v_exp_f32 v122, v122
    v_exp_f32 v123, v123
    s_waitcnt vmcnt(2)
    v_cvt_pk_bf16_f32 v6, v116, v117
    v_cvt_pk_bf16_f32 v7, v118, v119
    v_mfma_f32_32x32x16_bf16 v[104:119], v[136:139], v[8:11], 0
    v_exp_f32 v124, v124
    buffer_load_dwordx4 v[144:147], v1, s[28:31], s43 offen sc1
    v_exp_f32 v125, v125
    buffer_load_dwordx4 v[148:151], v1, s[28:31], s43 offen offset:1024 sc1
    v_exp_f32 v126, v126
    s_add_u32 s48, s48, 1
    v_exp_f32 v127, v127
    v_cvt_pk_bf16_f32 v120, v120, v121
    v_cvt_pk_bf16_f32 v121, v122, v123
    v_mfma_f32_32x32x16_bf16 v[104:119], v[140:143], v[12:15], v[104:119]
    v_exp_f32 v128, v128
    v_exp_f32 v129, v129
    v_exp_f32 v130, v130
    v_exp_f32 v131, v131
    v_cvt_pk_bf16_f32 v122, v124, v125
    v_cvt_pk_bf16_f32 v123, v126, v127
    v_mfma_f32_32x32x16_bf16 v[72:87], v[164:167], v[4:7], v[72:87]
    v_exp_f32 v132, v132
    v_exp_f32 v133, v133
    v_exp_f32 v134, v134
    v_exp_f32 v135, v135
    s_cmp_lt_u32 s48, 4
    v_cvt_pk_bf16_f32 v4, v128, v129
    v_cvt_pk_bf16_f32 v5, v130, v131
    s_cbranch_scc1 att_loop
    v_mfma_f32_32x32x16_bf16 v[88:103], v[160:163], v[120:123], v[88:103]
    v_cvt_pk_bf16_f32 v6, v132, v133
    v_cvt_pk_bf16_f32 v7, v134, v135
    s_nop 1
    v_mfma_f32_32x32x16_bf16 v[88:103], v[164:167], v[4:7], v[88:103]
    s_setprio 3
    s_cmp_lg_u32 s51, 0
    s_cbranch_scc1 att_nolend
    v_mov_b32 v2, 163584
    v_mov_b32 v3, 1
    s_mov_b64 exec, 1
    ds_add_u32 v2, v3 offset:48
    s_mov_b64 exec, -1
att_nolend:
    v_mov_b32 v3, 163584
att_udone:
    ds_read2_b32 v[104:105], v3 offset0:2 offset1:5
    s_waitcnt lgkmcnt(0)
    v_readfirstlane_b32 s3, v105
    v_readfirstlane_b32 s19, v104
    s_cmp_ge_u32 s3, 4
    s_cbranch_scc1 att_udone_ok
    s_sub_u32 s18, s18, 1
    s_cbranch_scc0 att_udone
    s_mov_b32 s18, 0
att_udone_ok:
    s_lshl_b32 s3, s22, 13
    s_add_u32 s3, s3, 90112
    v_add_u32 v2, s3, v1
    s_lshl_b32 s3, s22, 9
    s_add_u32 s3, s3, 155648
    v_lshrrev_b32 v3, 2, v1
    v_and_b32 v4, 127, v3
    v_add_u32 v4, s3, v4
    s_mov_b32 s46, 0x6c800000
    s_mov_b64 s[56:57], 0
    s_mov_b32 exec_lo, 0
    ds_write_b32 v4, v52 offset:0
    v_cmp_nge_f32 vcc, s46, v52
    s_mov_b32 exec_lo, -1
    s_or_b64 s[56:57], s[56:57], vcc
    v_cvt_pk_bf16_f32 v104, v40, v41
    v_cvt_pk_bf16_f32 v105, v42, v43
    v_cvt_pk_bf16_f32 v106, v44, v45
    v_cvt_pk_bf16_f32 v107, v46, v47
    v_cvt_pk_bf16_f32 v108, v48, v49
    v_cvt_pk_bf16_f32 v109, v50, v51
    v_cvt_pk_bf16_f32 v110, v52, v53
    v_cvt_pk_bf16_f32 v111, v54, v55
    ds_write_b128 v2, v[104:107] offset:0
    ds_write_b128 v2, v[108:111] offset:1024
    s_mov_b32 exec_lo, 0
    ds_write_b32 v4, v68 offset:128
    v_cmp_nge_f32 vcc, s46, v68
    s_mov_b32 exec_lo, -1
    s_or_b64 s[56:57], s[56:57], vcc
    v_cvt_pk_bf16_f32 v112, v56, v57
    v_cvt_pk_bf16_f32 v113, v58, v59
    v_cvt_pk_bf16_f32 v114, v60, v61
    v_cvt_pk_bf16_f32 v115, v62, v63
    v_cvt_pk_bf16_f32 v116, v64, v65
    v_cvt_pk_bf16_f32 v117, v66, v67
    v_cvt_pk_bf16_f32 v118, v68, v69
    v_cvt_pk_bf16_f32 v119, v70, v71
    ds_write_b128 v2, v[112:115] offset:2048
    ds_write_b128 v2, v[116:119] offset:3072
    s_mov_b32 exec_lo, 0
    ds_write_b32 v4, v84 offset:256
    v_cmp_nge_f32 vcc, s46, v84
    s_mov_b32 exec_lo, -1
    s_or_b64 s[56:57], s[56:57], vcc
    v_cvt_pk_bf16_f32 v120, v72, v73
    v_cvt_pk_bf16_f32 v121, v74, v75
    v_cvt_pk_bf16_f32 v122, v76, v77
    v_cvt_pk_bf16_f32 v123, v78, v79
    v_cvt_pk_bf16_f32 v124, v80, v81
    v_cvt_pk_bf16_f32 v125, v82, v83
    v_cvt_pk_bf16_f32 v126, v84, v85
    v_cvt_pk_bf16_f32 v127, v86, v87
    ds_write_b128 v2, v[120:123] offset:4096
    ds_write_b128 v2, v[124:127] offset:5120
    s_nop 3
    s_mov_b32 exec_lo, 0
    ds_write_b32 v4, v100 offset:384
    v_cmp_nge_f32 vcc, s46, v100
    s_mov_b32 exec_lo, -1
    s_or_b64 s[56:57], s[56:57], vcc
    v_cvt_pk_bf16_f32 v128, v88, v89
    v_cvt_pk_bf16_f32 v129, v90, v91
    v_cvt_pk_bf16_f32 v130, v92, v93
    v_cvt_pk_bf16_f32 v131, v94, v95
    v_cvt_pk_bf16_f32 v132, v96, v97
    v_cvt_pk_bf16_f32 v133, v98, v99
    v_cvt_pk_bf16_f32 v134, v100, v101
    v_cvt_pk_bf16_f32 v135, v102, v103
    ds_write_b128 v2, v[128:131] offset:6144
    ds_write_b128 v2, v[132:135] offset:7168
    v_mov_b32 v3, 163584
    s_cmp_eq_u64 s[56:57], 0
    s_cbranch_scc1 att_safe
    v_mov_b32 v2, 1
    s_mov_b64 exec, 1
    ds_add_u32 v3, v2 offset:12
    s_mov_b64 exec, -1
att_safe:
    s_add_u32 s44, s44, 8
    v_mov_b32 v2, 1
    s_waitcnt lgkmcnt(0)
    s_mov_b64 exec, 1
    ds_add_u32 v3, v2 offset:0
    s_mov_b64 exec, -1
att_b1:
    ds_read_b32 v2, v3 offset:0
    s_waitcnt lgkmcnt(0)
    v_readfirstlane_b32 s3, v2
    s_cmp_ge_u32 s3, s44
    s_cbranch_scc1 att_b1_ok
    s_sleep 1
    s_sub_u32 s18, s18, 1
    s_cbranch_scc0 att_b1
    s_mov_b32 s18, 0
att_b1_ok:
    ds_read_b32 v2, v3 offset:12
    s_lshl_b32 s3, s22, 10
    s_add_u32 s3, s3, 90112
    v_add_u32 v4, s3, v1
    ds_read_b128 v[40:43], v4 offset:0
    ds_read_b128 v[44:47], v4 offset:8192
    ds_read_b128 v[48:51], v4 offset:16384
    ds_read_b128 v[52:55], v4 offset:24576
    ds_read_b128 v[56:59], v4 offset:32768
    ds_read_b128 v[60:63], v4 offset:40960
    ds_read_b128 v[64:67], v4 offset:49152
    ds_read_b128 v[68:71], v4 offset:57344
    s_lshr_b32 s45, s22, 1
    s_lshl_b32 s3, s45, 7
    s_add_u32 s3, s3, 155648
    v_lshrrev_b32 v3, 2, v1
    v_and_b32 v3, 127, v3
    v_add_u32 v3, s3, v3
    s_waitcnt lgkmcnt(8)
    v_readfirstlane_b32 s3, v2
    s_cmp_lg_u32 s3, 0
    s_cselect_b32 s3, 1, 0
    s_andn2_b32 s3, s3, s51
    s_cbranch_scc1 att_fallback
    v_add_u32 v2, 162560, v1
    ds_read_b128 v[80:83], v2
    ds_read_b32 v72, v3 offset:0
    ds_read_b32 v73, v3 offset:512
    ds_read_b32 v74, v3 offset:1024
    ds_read_b32 v75, v3 offset:1536
    ds_read_b32 v76, v3 offset:2048
    ds_read_b32 v77, v3 offset:2560
    s_waitcnt lgkmcnt(6)
    ds_read_b32 v78, v3 offset:3072
    ds_read_b32 v79, v3 offset:3584
    v_mfma_f32_32x32x16_bf16 v[88:103], v[80:83], v[40:43], 0
    v_mfma_f32_32x32x16_bf16 v[88:103], v[80:83], v[44:47], v[88:103]
    v_mfma_f32_32x32x16_bf16 v[88:103], v[80:83], v[48:51], v[88:103]
    v_mfma_f32_32x32x16_bf16 v[88:103], v[80:83], v[52:55], v[88:103]
    v_mfma_f32_32x32x16_bf16 v[88:103], v[80:83], v[56:59], v[88:103]
    v_mfma_f32_32x32x16_bf16 v[88:103], v[80:83], v[60:63], v[88:103]
    v_mfma_f32_32x32x16_bf16 v[88:103], v[80:83], v[64:67], v[88:103]
    v_mfma_f32_32x32x16_bf16 v[88:103], v[80:83], v[68:71], v[88:103]
    s_lshr_b32 s3, s45, 1
    s_lshl_b32 s46, s20, 1
    s_add_u32 s3, s3, s46
    s_lshl_b32 s3, s3, 4
    s_lshl_b32 s46, s21, 1
    s_add_u32 s3, s3, s46
    s_and_b32 s46, s45, 1
    s_add_u32 s3, s3, s46
    s_lshl_b32 s3, s3, 11
    s_and_b32 s46, s22, 1
    s_lshl_b32 s46, s46, 10
    s_add_u32 s3, s3, s46
    s_add_u32 s47, s3, 524288
    s_waitcnt lgkmcnt(0)
    v_mov_b32 v2, 163584
    v_mov_b32 v3, 1
    s_mov_b64 exec, 1
    ds_add_u32 v2, v3 offset:44
    s_mov_b64 exec, -1
    v_add_f32 v72, v72, v73
    v_add_f32 v74, v74, v75
    v_add_f32 v76, v76, v77
    v_add_f32 v78, v78, v79
    v_add_f32 v72, v72, v74
    v_add_f32 v76, v76, v78
    v_add_f32 v72, v72, v76
    v_rcp_f32 v73, v72
    s_nop 3
    v_mul_f32 v88, v88, v73
    v_mul_f32 v89, v89, v73
    v_mul_f32 v90, v90, v73
    v_mul_f32 v91, v91, v73
    v_mul_f32 v92, v92, v73
    v_mul_f32 v93, v93, v73
    v_mul_f32 v94, v94, v73
    v_mul_f32 v95, v95, v73
    v_cvt_pk_bf16_f32 v40, v88, v89
    v_cvt_pk_bf16_f32 v41, v90, v91
    v_cvt_pk_bf16_f32 v42, v92, v93
    v_cvt_pk_bf16_f32 v43, v94, v95
    s_and_b32 s3, s22, 1
    s_cmp_eq_u32 s3, 1
    s_cselect_b32 exec_hi, -1, 0
    s_mov_b32 exec_lo, 0
    v_mov_b32 v42, 0
    v_mov_b32 v43, 0
    s_mov_b64 exec, -1
    buffer_store_dwordx4 v[40:43], v1, s[24:27], s47 offen sc1
    s_lshl_b32 s3, s20, 5
    s_add_u32 s3, s3, s21
    s_lshl_b32 s3, s3, 2
    s_add_u32 s3, s3, 274432
    v_mov_b32 v2, 163584
    v_mov_b32 v3, 1
    s_waitcnt vmcnt(0)
    s_mov_b64 exec, 1
    ds_add_rtn_u32 v3, v2, v3 offset:24
    s_waitcnt lgkmcnt(0)
    v_readfirstlane_b32 s60, v3
    s_mov_b64 exec, -1
    s_cmp_eq_u32 s60, 7
    s_cbranch_scc0 att_oflag
    s_mov_b64 exec, 1
    v_mov_b32 v2, s19
    v_mov_b32 v3, 0
    buffer_store_dword v2, v3, s[24:27], s3 offen sc1
    s_mov_b64 exec, -1
att_oflag:
    s_branch att_done
att_fallback:
    s_waitcnt lgkmcnt(0)
    s_mov_b32 s51, 1
    s_mov_b32 s30, 0x40000
    s_mov_b32 exec_lo, 0
    v_mov_b32 v14, 0
    v_mov_b32 v15, 0
    v_mov_b32 v22, 0
    v_mov_b32 v23, 0
    v_mov_b32 v30, 0
    v_mov_b32 v31, 0
    v_mov_b32 v38, 0
    v_mov_b32 v39, 0
    s_mov_b32 exec_lo, -1
    v_mov_b32 v4, 0xff800000
    v_mov_b32 v5, 0xff800000
    v_mov_b32 v6, 0xff800000
    v_mov_b32 v7, 0xff800000
    s_mov_b32 s43, 0
att_fb_loop:
    buffer_load_dwordx4 v[136:139], v1, s[28:31], s43 offen sc1
    buffer_load_dwordx4 v[140:143], v1, s[28:31], s43 offen offset:1024 sc1
    s_waitcnt vmcnt(0)
    v_mfma_f32_32x32x16_bf16 v[40:55], v[136:139], v[8:11], 0
    v_mfma_f32_32x32x16_bf16 v[40:55], v[140:143], v[12:15], v[40:55]
    v_mfma_f32_32x32x16_bf16 v[56:71], v[136:139], v[16:19], 0
    v_mfma_f32_32x32x16_bf16 v[56:71], v[140:143], v[20:23], v[56:71]
    v_mfma_f32_32x32x16_bf16 v[72:87], v[136:139], v[24:27], 0
    v_mfma_f32_32x32x16_bf16 v[72:87], v[140:143], v[28:31], v[72:87]
    v_mfma_f32_32x32x16_bf16 v[88:103], v[136:139], v[32:35], 0
    v_mfma_f32_32x32x16_bf16 v[88:103], v[140:143], v[36:39], v[88:103]
    s_nop 7
    v_max3_f32 v4, v4, v40, v41
    v_max3_f32 v4, v4, v42, v43
    v_max3_f32 v4, v4, v44, v45
    v_max3_f32 v4, v4, v46, v47
    v_max3_f32 v4, v4, v48, v49
    v_max3_f32 v4, v4, v50, v51
    v_max3_f32 v4, v4, v52, v53
    v_max3_f32 v4, v4, v54, v55
    v_max3_f32 v5, v5, v56, v57
    v_max3_f32 v5, v5, v58, v59
    v_max3_f32 v5, v5, v60, v61
    v_max3_f32 v5, v5, v62, v63
    v_max3_f32 v5, v5, v64, v65
    v_max3_f32 v5, v5, v66, v67
    v_max3_f32 v5, v5, v68, v69
    v_max3_f32 v5, v5, v70, v71
    v_max3_f32 v6, v6, v72, v73
    v_max3_f32 v6, v6, v74, v75
    v_max3_f32 v6, v6, v76, v77
    v_max3_f32 v6, v6, v78, v79
    v_max3_f32 v6, v6, v80, v81
    v_max3_f32 v6, v6, v82, v83
    v_max3_f32 v6, v6, v84, v85
    v_max3_f32 v6, v6, v86, v87
    v_max3_f32 v7, v7, v88, v89
    v_max3_f32 v7, v7, v90, v91
    v_max3_f32 v7, v7, v92, v93
    v_max3_f32 v7, v7, v94, v95
    v_max3_f32 v7, v7, v96, v97
    v_max3_f32 v7, v7, v98, v99
    v_max3_f32 v7, v7, v100, v101
    v_max3_f32 v7, v7, v102, v103
    s_add_u32 s43, s43, 4096
    s_cmp_lt_u32 s43, 0x40000
    s_cbranch_scc1 att_fb_loop
    v_mov_b32 v2, v4
    s_nop 1
    v_permlane32_swap_b32 v2, v4
    v_max_f32 v2, v2, v4
    v_sub_f32 v2, 0, v2
    v_cvt_pk_bf16_f32 v3, v2, v2
    v_and_b32 v3, 0xffff0000, v3
    v_sub_f32 v4, v2, v3
    v_cvt_pk_bf16_f32 v2, v4, v4
    v_and_b32 v2, 0xffff0000, v2
    v_sub_f32 v4, v4, v2
    v_cvt_pk_bf16_f32 v4, v4, 0
    v_lshrrev_b32 v3, 16, v3
    v_or_b32 v3, v3, v2
    s_mov_b32 exec_lo, 0
    v_mov_b32 v14, v3
    v_mov_b32 v15, v4
    s_mov_b32 exec_lo, -1
    v_mov_b32 v2, v5
    s_nop 1
    v_permlane32_swap_b32 v2, v5
    v_max_f32 v2, v2, v5
    v_sub_f32 v2, 0, v2
    v_cvt_pk_bf16_f32 v3, v2, v2
    v_and_b32 v3, 0xffff0000, v3
    v_sub_f32 v5, v2, v3
    v_cvt_pk_bf16_f32 v2, v5, v5
    v_and_b32 v2, 0xffff0000, v2
    v_sub_f32 v5, v5, v2
    v_cvt_pk_bf16_f32 v5, v5, 0
    v_lshrrev_b32 v3, 16, v3
    v_or_b32 v3, v3, v2
    s_mov_b32 exec_lo, 0
    v_mov_b32 v22, v3
    v_mov_b32 v23, v5
    s_mov_b32 exec_lo, -1
    v_mov_b32 v2, v6
    s_nop 1
    v_permlane32_swap_b32 v2, v6
    v_max_f32 v2, v2, v6
    v_sub_f32 v2, 0, v2
    v_cvt_pk_bf16_f32 v3, v2, v2
    v_and_b32 v3, 0xffff0000, v3
    v_sub_f32 v6, v2, v3
    v_cvt_pk_bf16_f32 v2, v6, v6
    v_and_b32 v2, 0xffff0000, v2
    v_sub_f32 v6, v6, v2
    v_cvt_pk_bf16_f32 v6, v6, 0
    v_lshrrev_b32 v3, 16, v3
    v_or_b32 v3, v3, v2
    s_mov_b32 exec_lo, 0
    v_mov_b32 v30, v3
    v_mov_b32 v31, v6
    s_mov_b32 exec_lo, -1
    v_mov_b32 v2, v7
    s_nop 1
    v_permlane32_swap_b32 v2, v7
    v_max_f32 v2, v2, v7
    v_sub_f32 v2, 0, v2
    v_cvt_pk_bf16_f32 v3, v2, v2
    v_and_b32 v3, 0xffff0000, v3
    v_sub_f32 v7, v2, v3
    v_cvt_pk_bf16_f32 v2, v7, v7
    v_and_b32 v2, 0xffff0000, v2
    v_sub_f32 v7, v7, v2
    v_cvt_pk_bf16_f32 v7, v7, 0
    v_lshrrev_b32 v3, 16, v3
    v_or_b32 v3, v3, v2
    s_mov_b32 exec_lo, 0
    v_mov_b32 v38, v3
    v_mov_b32 v39, v7
    s_mov_b32 exec_lo, -1
    v_mov_b32 v3, 163584
    s_add_u32 s44, s44, 8
    v_mov_b32 v2, 1
    s_waitcnt lgkmcnt(0)
    s_mov_b64 exec, 1
    ds_add_u32 v3, v2 offset:0
    s_mov_b64 exec, -1
att_bf:
    ds_read_b32 v2, v3 offset:0
    s_waitcnt lgkmcnt(0)
    v_readfirstlane_b32 s3, v2
    s_cmp_ge_u32 s3, s44
    s_cbranch_scc1 att_bf_ok
    s_sleep 1
    s_sub_u32 s18, s18, 1
    s_cbranch_scc0 att_bf
    s_mov_b32 s18, 0
att_bf_ok:
    s_branch att_restart
att_done:
    s_branch L_end
p1_bg:
    s_setprio 3
    s_mov_b32 s44, 0
    s_lshl_b32 s37, s21, 1
    s_and_b32 s3, s23, 1
    s_add_u32 s37, s37, s3
    s_lshr_b32 s38, s23, 1
    s_mov_b32 s28, s66
    s_mov_b32 s29, s67
    s_mov_b32 s30, 0x62000
    s_mov_b32 s31, 0x00020000
    v_lshrrev_b32 v20, 3, v0
    v_mul_u32_u24 v20, 896, v20
    v_and_b32 v21, 7, v0
    v_lshl_add_u32 v20, v21, 4, v20
    s_mul_i32 s32, s23, 100352
    s_mul_i32 s33, s21, 112
    s_add_u32 s32, s32, s33
    s_mul_i32 s34, s23, 14336
    s_add_u32 s34, s34, 57344
    s_mov_b32 m0, s34
    s_mov_b32 s36, 14
bg_qdma:
    s_sub_u32 s36, s36, 1
    buffer_load_dwordx4 v20, s[28:31], s32 offen lds
    s_add_u32 s32, s32, 7168
    s_add_u32 m0, m0, 1024
    s_cmp_lg_u32 s36, 0
    s_cbranch_scc1 bg_qdma
    s_mov_b32 s17, 0
    s_cmp_gt_u32 s23, 1
    s_cbranch_scc1 bg_nob
    s_cmp_eq_u32 s23, 0
    s_cselect_b32 s56, s80, s82
    s_cselect_b32 s57, s81, s83
    s_mov_b32 s48, s56
    s_mov_b32 s49, s57
    s_mov_b32 s50, 0x62000
    s_mov_b32 s51, 0x00020000
    s_lshr_b32 s3, s2, 3
    s_mul_i32 s3, s3, 12544
    v_lshlrev_b32 v21, 7, v0
    s_mov_b32 m0, 161792
    s_nop 0
    buffer_load_dword v21, s[48:51], s3 offen lds
    s_add_u32 s3, s3, 8192
    s_mov_b32 exec_hi, 3
    buffer_load_dword v21, s[48:51], s3 offen lds
    s_mov_b64 exec, -1
    s_mov_b32 s17, 1
bg_nob:
    s_cmp_eq_u32 s21, 7
    s_cbranch_scc1 bg_skip
    v_mov_b32 v16, 163584
bg_xr:
    ds_read_b32 v17, v16 offset:28
    s_waitcnt lgkmcnt(0)
    v_readfirstlane_b32 s3, v17
    s_cmp_ge_u32 s3, 8
    s_cbranch_scc1 bg_xr_ok
    s_sleep 1
    s_sub_u32 s18, s18, 1
    s_cbranch_scc0 bg_xr
    s_mov_b32 s18, 0
bg_xr_ok:
    v_bfe_u32 v16, v0, 2, 2
    v_lshrrev_b32 v6, 5, v0
    v_xor_b32 v16, v16, v6
    v_lshlrev_b32 v16, 4, v16
    v_and_b32 v6, 31, v0
    v_lshl_add_u32 v6, v6, 6, v16
    s_lshl_b32 s3, s38, 11
    v_add_u32 v6, s3, v6
    v_xor_b32 v7, 32, v6
    ds_read_b128 v[56:59], v6 offset:0
    ds_read_b128 v[60:63], v7 offset:0
    ds_read_b128 v[64:67], v6 offset:4096
    ds_read_b128 v[68:71], v7 offset:4096
    ds_read_b128 v[72:75], v6 offset:8192
    ds_read_b128 v[76:79], v7 offset:8192
    ds_read_b128 v[80:83], v6 offset:12288
    ds_read_b128 v[84:87], v7 offset:12288
    ds_read_b128 v[88:91], v6 offset:16384
    ds_read_b128 v[92:95], v7 offset:16384
    ds_read_b128 v[96:99], v6 offset:20480
    ds_read_b128 v[100:103], v7 offset:20480
    s_waitcnt lgkmcnt(2)
    ds_read_b128 v[104:107], v6 offset:24576
    ds_read_b128 v[108:111], v7 offset:24576
    ds_read_b128 v[112:115], v6 offset:28672
    ds_read_b128 v[116:119], v7 offset:28672
    ds_read_b128 v[120:123], v6 offset:32768
    ds_read_b128 v[124:127], v7 offset:32768
    ds_read_b128 v[128:131], v6 offset:36864
    ds_read_b128 v[132:135], v7 offset:36864
    ds_read_b128 v[136:139], v6 offset:40960
    ds_read_b128 v[140:143], v7 offset:40960
    s_waitcnt lgkmcnt(2)
    ds_read_b128 v[144:147], v6 offset:45056
    ds_read_b128 v[148:151], v7 offset:45056
    ds_read_b128 v[152:155], v6 offset:49152
    ds_read_b128 v[156:159], v7 offset:49152
    ds_read_b128 v[160:163], v6 offset:53248
    ds_read_b128 v[164:167], v7 offset:53248
    s_cmp_eq_u32 s17, 0
    s_cbranch_scc1 bg_pw0
    s_waitcnt vmcnt(16)
bg_pw0:
    s_cmp_lg_u32 s17, 0
    s_cbranch_scc1 bg_pw1
    s_waitcnt vmcnt(14)
bg_pw1:
    v_lshlrev_b32 v8, 16, v8
    v_lshlrev_b32 v9, 16, v9
    v_lshlrev_b32 v10, 16, v10
    v_mul_f32 v10, 0x3fb8aa3b, v10
    v_exp_f32 v10, v10
    s_nop 0
    v_cvt_pk_bf16_f32 v10, v10, v10
    v_lshlrev_b32 v10, 16, v10
    v_mul_f32 v11, v10, v8
    v_mul_f32 v12, v10, v9
    v_mul_f32 v11, 0x3fb8aa3b, v11
    v_mul_f32 v12, 0x3e22f983, v12
    v_exp_f32 v13, v11
    v_fract_f32 v14, v12
    s_nop 0
    v_cos_f32 v2, v14
    v_sin_f32 v3, v14
    s_nop 0
    v_mul_f32 v2, v2, v13
    v_mul_f32 v3, v3, v13
    v_add_f32 v13, -1.0, v2
    v_mul_f32 v14, v8, v8
    v_fma_f32 v14, v9, v9, v14
    v_rcp_f32 v14, v14
    v_mul_f32 v15, v13, v8
    v_fma_f32 v15, v3, v9, v15
    v_mul_f32 v16, v3, v8
    v_fma_f32 v16, -v13, v9, v16
    v_mul_f32 v4, v15, v14
    v_mul_f32 v5, v16, v14
    s_waitcnt lgkmcnt(0)
    v_mov_b32 v16, 163584
    v_mov_b32 v17, 1
    s_mov_b64 exec, 1
    ds_add_u32 v16, v17 offset:84
    s_mov_b64 exec, -1
    s_cmp_eq_u32 s17, 0
    s_cbranch_scc1 bg_qw0
    s_waitcnt vmcnt(2)
bg_qw0:
    s_cmp_lg_u32 s17, 0
    s_cbranch_scc1 bg_qw1
    s_waitcnt vmcnt(0)
bg_qw1:
    v_mov_b32 v16, 163584
    v_mov_b32 v17, 1
    s_mov_b64 exec, 1
    ds_add_u32 v16, v17 offset:88
    s_mov_b64 exec, -1
    s_and_b32 s3, s23, 1
    s_cmp_eq_u32 s3, 0
    s_cselect_b32 s28, s80, s82
    s_cselect_b32 s29, s81, s83
    s_mov_b32 s30, 401408
    s_mov_b32 s31, 0x00020000
    v_lshrrev_b32 v21, 4, v0
    v_and_b32 v20, 3, v0
    v_xor_b32 v20, v20, v21
    v_lshlrev_b32 v20, 4, v20
    v_lshrrev_b32 v21, 2, v0
    v_mul_u32_u24 v21, 896, v21
    v_add_u32 v20, v20, v21
    s_lshl_b32 s3, s21, 1
    s_add_u32 s3, s3, s38
    s_mul_i32 s32, s3, 28672
    v_mov_b32 v16, 163584
bg_xf:
    ds_read_b32 v17, v16 offset:84
    s_waitcnt lgkmcnt(0)
    v_readfirstlane_b32 s3, v17
    s_cmp_ge_u32 s3, 12
    s_cbranch_scc1 bg_xf_ok
    s_sleep 1
    s_sub_u32 s18, s18, 1
    s_cbranch_scc0 bg_xf
    s_mov_b32 s18, 0
bg_xf_ok:
    s_lshl_b32 s34, s23, 11
    s_mov_b32 m0, s34
    s_mov_b32 s36, 7
bg_bdma1:
    s_add_u32 s33, s32, 14336
    buffer_load_dwordx4 v20, s[28:31], s32 offen lds
    s_add_u32 m0, m0, 1024
    s_sub_u32 s36, s36, 1
    buffer_load_dwordx4 v20, s[28:31], s33 offen lds
    s_add_u32 s32, s32, 64
    s_add_u32 m0, m0, 7168
    s_cmp_lg_u32 s36, 0
    s_cbranch_scc1 bg_bdma1
    s_lshl_b32 s34, s23, 11
    s_add_u32 s34, s34, 114688
    s_mov_b32 m0, s34
    s_mov_b32 s36, 3
bg_bdma2:
    s_add_u32 s33, s32, 14336
    buffer_load_dwordx4 v20, s[28:31], s32 offen lds
    s_add_u32 m0, m0, 1024
    s_sub_u32 s36, s36, 1
    buffer_load_dwordx4 v20, s[28:31], s33 offen lds
    s_add_u32 s32, s32, 64
    s_add_u32 m0, m0, 7168
    s_cmp_lg_u32 s36, 0
    s_cbranch_scc1 bg_bdma2
    s_cmp_eq_u32 s23, 3
    s_cbranch_scc0 bg_noia
    s_mov_b32 s48, s96
    s_mov_b32 s49, s97
    s_mov_b32 s50, 0x100
    s_mov_b32 s51, 0x00020000
    v_mov_b32 v21, 0
    buffer_load_dword v22, v21, s[48:51], 0 offen offset:140 sc1
bg_noia:
    v_bfe_u32 v16, v0, 2, 2
    v_lshrrev_b32 v6, 5, v0
    v_xor_b32 v16, v16, v6
    v_lshlrev_b32 v16, 4, v16
    v_and_b32 v6, 31, v0
    v_lshl_add_u32 v6, v6, 6, v16
    s_and_b32 s3, s23, 1
    s_lshl_b32 s3, s3, 12
    v_add_u32 v6, s3, v6
    v_xor_b32 v7, 32, v6
    s_waitcnt vmcnt(0)
    s_cmp_eq_u32 s23, 3
    s_cbranch_scc0 bg_nona
    s_mov_b32 s48, s96
    s_mov_b32 s49, s97
    s_mov_b32 s50, 0x100
    s_mov_b32 s51, 0x00020000
bg_npa:
    v_readfirstlane_b32 s3, v22
    s_cmp_lg_u32 s3, 0
    s_cbranch_scc1 bg_npoka
    s_sleep 8
    v_mov_b32 v21, 0
    buffer_load_dword v22, v21, s[48:51], 0 offen offset:140 sc1
    s_waitcnt vmcnt(0)
    s_sub_u32 s18, s18, 1
    s_cbranch_scc0 bg_npa
    s_mov_b32 s18, 0
bg_npoka:
    v_mov_b32 v21, 163584
    ds_write_b32 v21, v22 offset:8
bg_nona:
    s_waitcnt lgkmcnt(0)
    v_mov_b32 v54, 163584
    s_add_u32 s44, s44, 4
    v_mov_b32 v55, 1
    s_waitcnt lgkmcnt(0)
    s_mov_b64 exec, 1
    ds_add_u32 v54, v55 offset:4
    s_mov_b64 exec, -1
bg_bar1:
    ds_read_b32 v55, v54 offset:4
    s_waitcnt lgkmcnt(0)
    v_readfirstlane_b32 s3, v55
    s_cmp_ge_u32 s3, s44
    s_cbranch_scc1 bg_bar1_ok
    s_sleep 1
    s_sub_u32 s18, s18, 1
    s_cbranch_scc0 bg_bar1
    s_mov_b32 s18, 0
bg_bar1_ok:
    ds_read_b32 v55, v54 offset:8
    s_waitcnt lgkmcnt(0)
    v_readfirstlane_b32 s19, v55
    v_mov_b32 v16, 163584
bg_qd2:
    ds_read_b32 v17, v16 offset:96
    s_waitcnt lgkmcnt(0)
    v_readfirstlane_b32 s3, v17
    s_cmp_ge_u32 s3, 4
    s_cbranch_scc1 bg_qd2_ok
    s_sleep 1
    s_sub_u32 s18, s18, 1
    s_cbranch_scc0 bg_qd2
    s_mov_b32 s18, 0
bg_qd2_ok:
    s_lshl_b32 s34, s23, 11
    s_add_u32 s34, s34, 57344
    s_mov_b32 m0, s34
    s_mov_b32 s36, 4
bg_bdma3:
    s_add_u32 s33, s32, 14336
    buffer_load_dwordx4 v20, s[28:31], s32 offen lds
    s_add_u32 m0, m0, 1024
    s_sub_u32 s36, s36, 1
    buffer_load_dwordx4 v20, s[28:31], s33 offen lds
    s_add_u32 s32, s32, 64
    s_add_u32 m0, m0, 7168
    s_cmp_lg_u32 s36, 0
    s_cbranch_scc1 bg_bdma3
    ds_read_b128 v[40:43], v6 offset:0
    ds_read_b128 v[44:47], v6 offset:2048
    ds_read_b128 v[48:51], v7 offset:0
    ds_read_b128 v[52:55], v7 offset:2048
    s_waitcnt lgkmcnt(2)
    v_mfma_f32_32x32x16_bf16 v[8:23], v[56:59], v[40:43], 0
    v_mfma_f32_32x32x16_bf16 v[24:39], v[56:59], v[44:47], 0
    ds_read_b128 v[40:43], v6 offset:8192
    ds_read_b128 v[44:47], v6 offset:10240
    s_waitcnt lgkmcnt(2)
    v_mfma_f32_32x32x16_bf16 v[8:23], v[60:63], v[48:51], v[8:23]
    v_mfma_f32_32x32x16_bf16 v[24:39], v[60:63], v[52:55], v[24:39]
    ds_read_b128 v[48:51], v7 offset:8192
    ds_read_b128 v[52:55], v7 offset:10240
    s_waitcnt lgkmcnt(2)
    v_mfma_f32_32x32x16_bf16 v[8:23], v[64:67], v[40:43], v[8:23]
    v_mfma_f32_32x32x16_bf16 v[24:39], v[64:67], v[44:47], v[24:39]
    ds_read_b128 v[40:43], v6 offset:16384
    ds_read_b128 v[44:47], v6 offset:18432
    s_waitcnt lgkmcnt(2)
    v_mfma_f32_32x32x16_bf16 v[8:23], v[68:71], v[48:51], v[8:23]
    v_mfma_f32_32x32x16_bf16 v[24:39], v[68:71], v[52:55], v[24:39]
    ds_read_b128 v[48:51], v7 offset:16384
    ds_read_b128 v[52:55], v7 offset:18432
    s_waitcnt lgkmcnt(2)
    v_mfma_f32_32x32x16_bf16 v[8:23], v[72:75], v[40:43], v[8:23]
    v_mfma_f32_32x32x16_bf16 v[24:39], v[72:75], v[44:47], v[24:39]
    ds_read_b128 v[40:43], v6 offset:24576
    ds_read_b128 v[44:47], v6 offset:26624
    s_waitcnt lgkmcnt(2)
    v_mfma_f32_32x32x16_bf16 v[8:23], v[76:79], v[48:51], v[8:23]
    v_mfma_f32_32x32x16_bf16 v[24:39], v[76:79], v[52:55], v[24:39]
    ds_read_b128 v[48:51], v7 offset:24576
    ds_read_b128 v[52:55], v7 offset:26624
    s_waitcnt lgkmcnt(2)
    v_mfma_f32_32x32x16_bf16 v[8:23], v[80:83], v[40:43], v[8:23]
    v_mfma_f32_32x32x16_bf16 v[24:39], v[80:83], v[44:47], v[24:39]
    ds_read_b128 v[40:43], v6 offset:32768
    ds_read_b128 v[44:47], v6 offset:34816
    s_waitcnt lgkmcnt(2)
    v_mfma_f32_32x32x16_bf16 v[8:23], v[84:87], v[48:51], v[8:23]
    v_mfma_f32_32x32x16_bf16 v[24:39], v[84:87], v[52:55], v[24:39]
    ds_read_b128 v[48:51], v7 offset:32768
    ds_read_b128 v[52:55], v7 offset:34816
    s_waitcnt lgkmcnt(2)
    v_mfma_f32_32x32x16_bf16 v[8:23], v[88:91], v[40:43], v[8:23]
    v_mfma_f32_32x32x16_bf16 v[24:39], v[88:91], v[44:47], v[24:39]
    ds_read_b128 v[40:43], v6 offset:40960
    ds_read_b128 v[44:47], v6 offset:43008
    s_waitcnt lgkmcnt(2)
    v_mfma_f32_32x32x16_bf16 v[8:23], v[92:95], v[48:51], v[8:23]
    v_mfma_f32_32x32x16_bf16 v[24:39], v[92:95], v[52:55], v[24:39]
    ds_read_b128 v[48:51], v7 offset:40960
    ds_read_b128 v[52:55], v7 offset:43008
    s_waitcnt lgkmcnt(2)
    v_mfma_f32_32x32x16_bf16 v[8:23], v[96:99], v[40:43], v[8:23]
    v_mfma_f32_32x32x16_bf16 v[24:39], v[96:99], v[44:47], v[24:39]
    ds_read_b128 v[40:43], v6 offset:49152
    ds_read_b128 v[44:47], v6 offset:51200
    s_waitcnt lgkmcnt(2)
    v_mfma_f32_32x32x16_bf16 v[8:23], v[100:103], v[48:51], v[8:23]
    v_mfma_f32_32x32x16_bf16 v[24:39], v[100:103], v[52:55], v[24:39]
    ds_read_b128 v[48:51], v7 offset:49152
    ds_read_b128 v[52:55], v7 offset:51200
    s_waitcnt lgkmcnt(2)
    v_mfma_f32_32x32x16_bf16 v[8:23], v[104:107], v[40:43], v[8:23]
    v_mfma_f32_32x32x16_bf16 v[24:39], v[104:107], v[44:47], v[24:39]
    v_add_u32 v6, 114688, v6
    ds_read_b128 v[40:43], v6 offset:0
    ds_read_b128 v[44:47], v6 offset:2048
    s_waitcnt lgkmcnt(2)
    v_mfma_f32_32x32x16_bf16 v[8:23], v[108:111], v[48:51], v[8:23]
    v_mfma_f32_32x32x16_bf16 v[24:39], v[108:111], v[52:55], v[24:39]
    v_add_u32 v7, 114688, v7
    ds_read_b128 v[48:51], v7 offset:0
    ds_read_b128 v[52:55], v7 offset:2048
    s_waitcnt lgkmcnt(2)
    v_mfma_f32_32x32x16_bf16 v[8:23], v[112:115], v[40:43], v[8:23]
    v_mfma_f32_32x32x16_bf16 v[24:39], v[112:115], v[44:47], v[24:39]
    ds_read_b128 v[40:43], v6 offset:8192
    ds_read_b128 v[44:47], v6 offset:10240
    s_waitcnt lgkmcnt(2)
    v_mfma_f32_32x32x16_bf16 v[8:23], v[116:119], v[48:51], v[8:23]
    v_mfma_f32_32x32x16_bf16 v[24:39], v[116:119], v[52:55], v[24:39]
    ds_read_b128 v[48:51], v7 offset:8192
    ds_read_b128 v[52:55], v7 offset:10240
    s_waitcnt lgkmcnt(2)
    v_mfma_f32_32x32x16_bf16 v[8:23], v[120:123], v[40:43], v[8:23]
    v_mfma_f32_32x32x16_bf16 v[24:39], v[120:123], v[44:47], v[24:39]
    ds_read_b128 v[40:43], v6 offset:16384
    ds_read_b128 v[44:47], v6 offset:18432
    s_waitcnt lgkmcnt(2)
    v_mfma_f32_32x32x16_bf16 v[8:23], v[124:127], v[48:51], v[8:23]
    v_mfma_f32_32x32x16_bf16 v[24:39], v[124:127], v[52:55], v[24:39]
    ds_read_b128 v[48:51], v7 offset:16384
    ds_read_b128 v[52:55], v7 offset:18432
    s_waitcnt lgkmcnt(2)
    v_mfma_f32_32x32x16_bf16 v[8:23], v[128:131], v[40:43], v[8:23]
    v_mfma_f32_32x32x16_bf16 v[24:39], v[128:131], v[44:47], v[24:39]
    s_waitcnt lgkmcnt(0)
    v_mfma_f32_32x32x16_bf16 v[8:23], v[132:135], v[48:51], v[8:23]
    v_mfma_f32_32x32x16_bf16 v[24:39], v[132:135], v[52:55], v[24:39]
    v_subrev_u32 v6, 57344, v6
    v_subrev_u32 v7, 57344, v7
    s_waitcnt vmcnt(0)
    v_mov_b32 v56, 163584
    s_add_u32 s44, s44, 4
    v_mov_b32 v57, 1
    s_waitcnt lgkmcnt(0)
    s_mov_b64 exec, 1
    ds_add_u32 v56, v57 offset:4
    s_mov_b64 exec, -1
bg_bar2:
    ds_read_b32 v57, v56 offset:4
    s_waitcnt lgkmcnt(0)
    v_readfirstlane_b32 s3, v57
    s_cmp_ge_u32 s3, s44
    s_cbranch_scc1 bg_bar2_ok
    s_sleep 1
    s_sub_u32 s18, s18, 1
    s_cbranch_scc0 bg_bar2
    s_mov_b32 s18, 0
bg_bar2_ok:
    ds_read_b128 v[40:43], v6 offset:0
    ds_read_b128 v[44:47], v6 offset:2048
    ds_read_b128 v[48:51], v7 offset:0
    ds_read_b128 v[52:55], v7 offset:2048
    s_waitcnt lgkmcnt(2)
    v_mfma_f32_32x32x16_bf16 v[8:23], v[136:139], v[40:43], v[8:23]
    v_mfma_f32_32x32x16_bf16 v[24:39], v[136:139], v[44:47], v[24:39]
    ds_read_b128 v[40:43], v6 offset:8192
    ds_read_b128 v[44:47], v6 offset:10240
    s_waitcnt lgkmcnt(2)
    v_mfma_f32_32x32x16_bf16 v[8:23], v[140:143], v[48:51], v[8:23]
    v_mfma_f32_32x32x16_bf16 v[24:39], v[140:143], v[52:55], v[24:39]
    ds_read_b128 v[48:51], v7 offset:8192
    ds_read_b128 v[52:55], v7 offset:10240
    s_waitcnt lgkmcnt(2)
    v_mfma_f32_32x32x16_bf16 v[8:23], v[144:147], v[40:43], v[8:23]
    v_mfma_f32_32x32x16_bf16 v[24:39], v[144:147], v[44:47], v[24:39]
    ds_read_b128 v[40:43], v6 offset:16384
    ds_read_b128 v[44:47], v6 offset:18432
    s_waitcnt lgkmcnt(2)
    v_mfma_f32_32x32x16_bf16 v[8:23], v[148:151], v[48:51], v[8:23]
    v_mfma_f32_32x32x16_bf16 v[24:39], v[148:151], v[52:55], v[24:39]
    ds_read_b128 v[48:51], v7 offset:16384
    ds_read_b128 v[52:55], v7 offset:18432
    s_waitcnt lgkmcnt(2)
    v_mfma_f32_32x32x16_bf16 v[8:23], v[152:155], v[40:43], v[8:23]
    v_mfma_f32_32x32x16_bf16 v[24:39], v[152:155], v[44:47], v[24:39]
    ds_read_b128 v[40:43], v6 offset:24576
    ds_read_b128 v[44:47], v6 offset:26624
    s_waitcnt lgkmcnt(2)
    v_mfma_f32_32x32x16_bf16 v[8:23], v[156:159], v[48:51], v[8:23]
    v_mfma_f32_32x32x16_bf16 v[24:39], v[156:159], v[52:55], v[24:39]
    ds_read_b128 v[48:51], v7 offset:24576
    ds_read_b128 v[52:55], v7 offset:26624
    s_waitcnt lgkmcnt(2)
    v_mfma_f32_32x32x16_bf16 v[8:23], v[160:163], v[40:43], v[8:23]
    v_mfma_f32_32x32x16_bf16 v[24:39], v[160:163], v[44:47], v[24:39]
    s_waitcnt lgkmcnt(0)
    v_mfma_f32_32x32x16_bf16 v[8:23], v[164:167], v[48:51], v[8:23]
    v_mfma_f32_32x32x16_bf16 v[24:39], v[164:167], v[52:55], v[24:39]
    v_mov_b32 v54, 163584
    v_mov_b32 v55, 1
    s_mov_b64 exec, 1
    ds_add_u32 v54, v55 offset:16
    s_mov_b64 exec, -1
    v_mul_f32 v46, v3, v3
    v_mul_f32 v47, v2, v3
    v_fma_f32 v40, v2, v2, -v46
    v_add_f32 v41, v47, v47
    v_mul_f32 v46, v41, v41
    v_mul_f32 v47, v40, v41
    v_fma_f32 v40, v40, v40, -v46
    v_add_f32 v41, v47, v47
    v_mul_f32 v46, v41, v41
    v_mul_f32 v47, v40, v41
    v_fma_f32 v40, v40, v40, -v46
    v_add_f32 v41, v47, v47
    v_mul_f32 v46, v41, v41
    v_mul_f32 v47, v40, v41
    v_fma_f32 v40, v40, v40, -v46
    v_add_f32 v41, v47, v47
    v_mul_f32 v46, v41, v41
    v_mul_f32 v47, v40, v41
    v_fma_f32 v42, v40, v40, -v46
    v_add_f32 v43, v47, v47
    v_mul_f32 v46, v43, v43
    v_mul_f32 v47, v42, v43
    v_fma_f32 v42, v42, v42, -v46
    v_add_f32 v43, v47, v47
    v_mul_f32 v46, v43, v43
    v_mul_f32 v47, v42, v43
    v_fma_f32 v44, v42, v42, -v46
    v_add_f32 v45, v47, v47
    v_mul_f32 v46, v45, v45
    v_mul_f32 v47, v44, v45
    v_fma_f32 v44, v44, v44, -v46
    v_add_f32 v45, v47, v47
    v_mul_f32 v46, v45, v45
    v_mul_f32 v47, v44, v45
    v_fma_f32 v44, v44, v44, -v46
    v_add_f32 v45, v47, v47
    v_mul_f32 v46, v45, v45
    v_mul_f32 v47, v44, v45
    v_fma_f32 v44, v44, v44, -v46
    v_add_f32 v45, v47, v47
    v_mov_b32 v48, v4
    v_mov_b32 v49, v4
    v_mov_b32 v50, v5
    v_mov_b32 v51, v5
    v_pk_mul_f32 v[46:47], v[50:51], v[24:25]
    v_pk_mul_f32 v[52:53], v[50:51], v[8:9]
    v_pk_fma_f32 v[8:9], v[48:49], v[8:9], v[46:47] neg_lo:[0,0,1] neg_hi:[0,0,1]
    v_pk_fma_f32 v[24:25], v[48:49], v[24:25], v[52:53]
    v_pk_mul_f32 v[46:47], v[50:51], v[26:27]
    v_pk_mul_f32 v[52:53], v[50:51], v[10:11]
    v_pk_fma_f32 v[10:11], v[48:49], v[10:11], v[46:47] neg_lo:[0,0,1] neg_hi:[0,0,1]
    v_pk_fma_f32 v[26:27], v[48:49], v[26:27], v[52:53]
    v_pk_mul_f32 v[46:47], v[50:51], v[28:29]
    v_pk_mul_f32 v[52:53], v[50:51], v[12:13]
    v_pk_fma_f32 v[12:13], v[48:49], v[12:13], v[46:47] neg_lo:[0,0,1] neg_hi:[0,0,1]
    v_pk_fma_f32 v[28:29], v[48:49], v[28:29], v[52:53]
    v_pk_mul_f32 v[46:47], v[50:51], v[30:31]
    v_pk_mul_f32 v[52:53], v[50:51], v[14:15]
    v_pk_fma_f32 v[14:15], v[48:49], v[14:15], v[46:47] neg_lo:[0,0,1] neg_hi:[0,0,1]
    v_pk_fma_f32 v[30:31], v[48:49], v[30:31], v[52:53]
    v_pk_mul_f32 v[46:47], v[50:51], v[32:33]
    v_pk_mul_f32 v[52:53], v[50:51], v[16:17]
    v_pk_fma_f32 v[16:17], v[48:49], v[16:17], v[46:47] neg_lo:[0,0,1] neg_hi:[0,0,1]
    v_pk_fma_f32 v[32:33], v[48:49], v[32:33], v[52:53]
    v_pk_mul_f32 v[46:47], v[50:51], v[34:35]
    v_pk_mul_f32 v[52:53], v[50:51], v[18:19]
    v_pk_fma_f32 v[18:19], v[48:49], v[18:19], v[46:47] neg_lo:[0,0,1] neg_hi:[0,0,1]
    v_pk_fma_f32 v[34:35], v[48:49], v[34:35], v[52:53]
    v_pk_mul_f32 v[46:47], v[50:51], v[36:37]
    v_pk_mul_f32 v[52:53], v[50:51], v[20:21]
    v_pk_fma_f32 v[20:21], v[48:49], v[20:21], v[46:47] neg_lo:[0,0,1] neg_hi:[0,0,1]
    v_pk_fma_f32 v[36:37], v[48:49], v[36:37], v[52:53]
    v_pk_mul_f32 v[46:47], v[50:51], v[38:39]
    v_pk_mul_f32 v[52:53], v[50:51], v[22:23]
    v_pk_fma_f32 v[22:23], v[48:49], v[22:23], v[46:47] neg_lo:[0,0,1] neg_hi:[0,0,1]
    v_pk_fma_f32 v[38:39], v[48:49], v[38:39], v[52:53]
    v_mov_b32 v48, v8
    v_mov_b32 v49, v24
    v_fma_f32 v46, -v3, v49, v9
    v_fma_f32 v47, v3, v48, v25
    v_fma_f32 v48, v2, v48, v46
    v_fma_f32 v49, v2, v49, v47
    v_fma_f32 v46, -v3, v49, v10
    v_fma_f32 v47, v3, v48, v26
    v_fma_f32 v48, v2, v48, v46
    v_fma_f32 v49, v2, v49, v47
    v_fma_f32 v46, -v3, v49, v11
    v_fma_f32 v47, v3, v48, v27
    v_fma_f32 v48, v2, v48, v46
    v_fma_f32 v49, v2, v49, v47
    v_fma_f32 v46, -v3, v49, v12
    v_fma_f32 v47, v3, v48, v28
    v_fma_f32 v48, v2, v48, v46
    v_fma_f32 v49, v2, v49, v47
    v_fma_f32 v46, -v3, v49, v13
    v_fma_f32 v47, v3, v48, v29
    v_fma_f32 v48, v2, v48, v46
    v_fma_f32 v49, v2, v49, v47
    v_fma_f32 v46, -v3, v49, v14
    v_fma_f32 v47, v3, v48, v30
    v_fma_f32 v48, v2, v48, v46
    v_fma_f32 v49, v2, v49, v47
    v_fma_f32 v46, -v3, v49, v15
    v_fma_f32 v47, v3, v48, v31
    v_fma_f32 v48, v2, v48, v46
    v_fma_f32 v49, v2, v49, v47
    v_fma_f32 v46, -v3, v49, v16
    v_fma_f32 v47, v3, v48, v32
    v_fma_f32 v48, v2, v48, v46
    v_fma_f32 v49, v2, v49, v47
    v_fma_f32 v46, -v3, v49, v17
    v_fma_f32 v47, v3, v48, v33
    v_fma_f32 v48, v2, v48, v46
    v_fma_f32 v49, v2, v49, v47
    v_fma_f32 v46, -v3, v49, v18
    v_fma_f32 v47, v3, v48, v34
    v_fma_f32 v48, v2, v48, v46
    v_fma_f32 v49, v2, v49, v47
    v_fma_f32 v46, -v3, v49, v19
    v_fma_f32 v47, v3, v48, v35
    v_fma_f32 v48, v2, v48, v46
    v_fma_f32 v49, v2, v49, v47
    v_fma_f32 v46, -v3, v49, v20
    v_fma_f32 v47, v3, v48, v36
    v_fma_f32 v48, v2, v48, v46
    v_fma_f32 v49, v2, v49, v47
    v_fma_f32 v46, -v3, v49, v21
    v_fma_f32 v47, v3, v48, v37
    v_fma_f32 v48, v2, v48, v46
    v_fma_f32 v49, v2, v49, v47
    v_fma_f32 v46, -v3, v49, v22
    v_fma_f32 v47, v3, v48, v38
    v_fma_f32 v48, v2, v48, v46
    v_fma_f32 v49, v2, v49, v47
    v_fma_f32 v46, -v3, v49, v23
    v_fma_f32 v47, v3, v48, v39
    v_fma_f32 v48, v2, v48, v46
    v_fma_f32 v49, v2, v49, v47
    v_and_b32 v50, 31, v0
    v_lshlrev_b32 v50, 3, v50
    s_and_b32 s3, s23, 1
    s_lshl_b32 s3, s3, 10
    s_add_u32 s3, s3, 159744
    v_add_u32 v50, s3, v50
    v_lshrrev_b32 v51, 5, v0
    s_lshl_b32 s3, s38, 1
    v_add_u32 v51, s3, v51
    v_lshl_add_u32 v52, v51, 8, v50
    ds_write_b64 v52, v[48:49]
    v_mov_b32 v54, 163584
    s_add_u32 s44, s44, 4
    v_mov_b32 v55, 1
    s_waitcnt lgkmcnt(0)
    s_mov_b64 exec, 1
    ds_add_u32 v54, v55 offset:4
    s_mov_b64 exec, -1
bg_bar3:
    ds_read_b32 v55, v54 offset:4
    s_waitcnt lgkmcnt(0)
    v_readfirstlane_b32 s3, v55
    s_cmp_ge_u32 s3, s44
    s_cbranch_scc1 bg_bar3_ok
    s_sleep 1
    s_sub_u32 s18, s18, 1
    s_cbranch_scc0 bg_bar3
    s_mov_b32 s18, 0
bg_bar3_ok:
    ds_read_b64 v[56:57], v50 offset:0
    ds_read_b64 v[58:59], v50 offset:256
    ds_read_b64 v[60:61], v50 offset:512
    ds_read_b64 v[62:63], v50 offset:768
    s_waitcnt lgkmcnt(0)
    v_mov_b32 v64, v56
    v_mov_b32 v65, v57
    v_fma_f32 v46, -v41, v65, v58
    v_fma_f32 v47, v41, v64, v59
    v_fma_f32 v64, v40, v64, v46
    v_fma_f32 v65, v40, v65, v47
    v_fma_f32 v46, -v41, v65, v60
    v_fma_f32 v47, v41, v64, v61
    v_fma_f32 v64, v40, v64, v46
    v_fma_f32 v65, v40, v65, v47
    v_fma_f32 v46, -v41, v65, v62
    v_fma_f32 v47, v41, v64, v63
    v_fma_f32 v64, v40, v64, v46
    v_fma_f32 v65, v40, v65, v47
    s_cmp_eq_u32 s38, 1
    s_cbranch_scc0 bg_nopub
    s_mul_i32 s3, s20, 7168
    s_lshl_b32 s33, s37, 9
    s_add_u32 s3, s3, s33
    s_add_u32 s3, s3, 294912
    v_mov_b32 v66, s19
    v_mov_b32 v67, s19
    v_and_b32 v68, 31, v0
    v_lshlrev_b32 v68, 4, v68
    s_mov_b32 exec_hi, 0
    buffer_store_dwordx4 v[64:67], v68, s[24:27], s3 offen sc1
    s_mov_b64 exec, -1
bg_nopub:
    s_add_u32 s48, s24, 294912
    s_addc_u32 s49, s25, 0
    s_mov_b32 s50, 229376
    s_mov_b32 s51, 0x00020000
    v_lshrrev_b32 v67, 5, v0
    v_lshlrev_b32 v67, 4, v67
    v_sub_u32 v67, s20, v67
    v_add_u32 v67, -1, v67
    s_mov_b32 s3, 7168
    v_mul_lo_u32 v68, v67, s3
    v_and_b32 v66, 31, v0
    v_lshlrev_b32 v66, 4, v66
    s_lshl_b32 s33, s37, 9
    v_add3_u32 v68, v68, v66, s33
    v_subrev_u32 v137, 7168, v68
    v_subrev_u32 v138, 14336, v68
    v_subrev_u32 v139, 21504, v68
    v_subrev_u32 v140, 28672, v68
    v_subrev_u32 v141, 35840, v68
    v_subrev_u32 v142, 43008, v68
    v_subrev_u32 v143, 50176, v68
    v_subrev_u32 v144, 57344, v68
    v_subrev_u32 v145, 64512, v68
    v_subrev_u32 v146, 71680, v68
    v_subrev_u32 v147, 78848, v68
    v_subrev_u32 v148, 86016, v68
    v_subrev_u32 v149, 93184, v68
    v_subrev_u32 v150, 100352, v68
    v_subrev_u32 v151, 107520, v68
    v_mov_b32 v136, v68
    s_waitcnt vmcnt(0)
    s_cmp_eq_u32 s20, 0
    s_cbranch_scc1 bg_pollE
bg_pollE0:
    s_mov_b32 exec_hi, 0
    buffer_load_dwordx3 v[72:74], v136, s[48:51], 0 offen sc1
    s_mov_b64 exec, -1
    s_waitcnt vmcnt(0)
    v_cmp_ne_u32 vcc, s19, v74
    s_cmp_eq_u32 vcc_lo, 0
    s_cbranch_scc1 bg_pollE
    s_sleep 6
    s_sub_u32 s18, s18, 1
    s_cbranch_scc0 bg_pollE0
    s_mov_b32 s18, 0
bg_pollE:
    buffer_load_dwordx3 v[72:74], v136, s[48:51], 0 offen sc1
    buffer_load_dwordx3 v[76:78], v137, s[48:51], 0 offen sc1
    buffer_load_dwordx3 v[80:82], v138, s[48:51], 0 offen sc1
    buffer_load_dwordx3 v[84:86], v139, s[48:51], 0 offen sc1
    buffer_load_dwordx3 v[88:90], v140, s[48:51], 0 offen sc1
    buffer_load_dwordx3 v[92:94], v141, s[48:51], 0 offen sc1
    buffer_load_dwordx3 v[96:98], v142, s[48:51], 0 offen sc1
    buffer_load_dwordx3 v[100:102], v143, s[48:51], 0 offen sc1
    buffer_load_dwordx3 v[104:106], v144, s[48:51], 0 offen sc1
    buffer_load_dwordx3 v[108:110], v145, s[48:51], 0 offen sc1
    buffer_load_dwordx3 v[112:114], v146, s[48:51], 0 offen sc1
    buffer_load_dwordx3 v[116:118], v147, s[48:51], 0 offen sc1
    buffer_load_dwordx3 v[120:122], v148, s[48:51], 0 offen sc1
    buffer_load_dwordx3 v[124:126], v149, s[48:51], 0 offen sc1
    buffer_load_dwordx3 v[128:130], v150, s[48:51], 0 offen sc1
    buffer_load_dwordx3 v[132:134], v151, s[48:51], 0 offen sc1
    s_mov_b64 s[56:57], 0
    s_waitcnt vmcnt(0)
    v_cmp_ne_u32 vcc, s19, v74
    s_cmp_gt_u32 s20, 0
    s_cselect_b32 s58, -1, 0
    s_cmp_gt_u32 s20, 16
    s_cselect_b32 s59, -1, 0
    s_and_b64 vcc, vcc, s[58:59]
    s_or_b64 s[56:57], s[56:57], vcc
    v_cmp_ne_u32 vcc, s19, v78
    s_cmp_gt_u32 s20, 1
    s_cselect_b32 s58, -1, 0
    s_cmp_gt_u32 s20, 17
    s_cselect_b32 s59, -1, 0
    s_and_b64 vcc, vcc, s[58:59]
    s_or_b64 s[56:57], s[56:57], vcc
    v_cmp_ne_u32 vcc, s19, v82
    s_cmp_gt_u32 s20, 2
    s_cselect_b32 s58, -1, 0
    s_cmp_gt_u32 s20, 18
    s_cselect_b32 s59, -1, 0
    s_and_b64 vcc, vcc, s[58:59]
    s_or_b64 s[56:57], s[56:57], vcc
    v_cmp_ne_u32 vcc, s19, v86
    s_cmp_gt_u32 s20, 3
    s_cselect_b32 s58, -1, 0
    s_cmp_gt_u32 s20, 19
    s_cselect_b32 s59, -1, 0
    s_and_b64 vcc, vcc, s[58:59]
    s_or_b64 s[56:57], s[56:57], vcc
    v_cmp_ne_u32 vcc, s19, v90
    s_cmp_gt_u32 s20, 4
    s_cselect_b32 s58, -1, 0
    s_cmp_gt_u32 s20, 20
    s_cselect_b32 s59, -1, 0
    s_and_b64 vcc, vcc, s[58:59]
    s_or_b64 s[56:57], s[56:57], vcc
    v_cmp_ne_u32 vcc, s19, v94
    s_cmp_gt_u32 s20, 5
    s_cselect_b32 s58, -1, 0
    s_cmp_gt_u32 s20, 21
    s_cselect_b32 s59, -1, 0
    s_and_b64 vcc, vcc, s[58:59]
    s_or_b64 s[56:57], s[56:57], vcc
    v_cmp_ne_u32 vcc, s19, v98
    s_cmp_gt_u32 s20, 6
    s_cselect_b32 s58, -1, 0
    s_cmp_gt_u32 s20, 22
    s_cselect_b32 s59, -1, 0
    s_and_b64 vcc, vcc, s[58:59]
    s_or_b64 s[56:57], s[56:57], vcc
    v_cmp_ne_u32 vcc, s19, v102
    s_cmp_gt_u32 s20, 7
    s_cselect_b32 s58, -1, 0
    s_cmp_gt_u32 s20, 23
    s_cselect_b32 s59, -1, 0
    s_and_b64 vcc, vcc, s[58:59]
    s_or_b64 s[56:57], s[56:57], vcc
    v_cmp_ne_u32 vcc, s19, v106
    s_cmp_gt_u32 s20, 8
    s_cselect_b32 s58, -1, 0
    s_cmp_gt_u32 s20, 24
    s_cselect_b32 s59, -1, 0
    s_and_b64 vcc, vcc, s[58:59]
    s_or_b64 s[56:57], s[56:57], vcc
    v_cmp_ne_u32 vcc, s19, v110
    s_cmp_gt_u32 s20, 9
    s_cselect_b32 s58, -1, 0
    s_cmp_gt_u32 s20, 25
    s_cselect_b32 s59, -1, 0
    s_and_b64 vcc, vcc, s[58:59]
    s_or_b64 s[56:57], s[56:57], vcc
    v_cmp_ne_u32 vcc, s19, v114
    s_cmp_gt_u32 s20, 10
    s_cselect_b32 s58, -1, 0
    s_cmp_gt_u32 s20, 26
    s_cselect_b32 s59, -1, 0
    s_and_b64 vcc, vcc, s[58:59]
    s_or_b64 s[56:57], s[56:57], vcc
    v_cmp_ne_u32 vcc, s19, v118
    s_cmp_gt_u32 s20, 11
    s_cselect_b32 s58, -1, 0
    s_cmp_gt_u32 s20, 27
    s_cselect_b32 s59, -1, 0
    s_and_b64 vcc, vcc, s[58:59]
    s_or_b64 s[56:57], s[56:57], vcc
    v_cmp_ne_u32 vcc, s19, v122
    s_cmp_gt_u32 s20, 12
    s_cselect_b32 s58, -1, 0
    s_cmp_gt_u32 s20, 28
    s_cselect_b32 s59, -1, 0
    s_and_b64 vcc, vcc, s[58:59]
    s_or_b64 s[56:57], s[56:57], vcc
    v_cmp_ne_u32 vcc, s19, v126
    s_cmp_gt_u32 s20, 13
    s_cselect_b32 s58, -1, 0
    s_cmp_gt_u32 s20, 29
    s_cselect_b32 s59, -1, 0
    s_and_b64 vcc, vcc, s[58:59]
    s_or_b64 s[56:57], s[56:57], vcc
    v_cmp_ne_u32 vcc, s19, v130
    s_cmp_gt_u32 s20, 14
    s_cselect_b32 s58, -1, 0
    s_cmp_gt_u32 s20, 30
    s_cselect_b32 s59, -1, 0
    s_and_b64 vcc, vcc, s[58:59]
    s_or_b64 s[56:57], s[56:57], vcc
    v_cmp_ne_u32 vcc, s19, v134
    s_cmp_gt_u32 s20, 15
    s_cselect_b32 s58, -1, 0
    s_cmp_gt_u32 s20, 31
    s_cselect_b32 s59, -1, 0
    s_and_b64 vcc, vcc, s[58:59]
    s_or_b64 s[56:57], s[56:57], vcc
    s_cmp_eq_u64 s[56:57], 0
    s_cbranch_scc1 bg_pollE_ok
    s_sleep 12
    s_sub_u32 s18, s18, 1
    s_cbranch_scc0 bg_pollE
    s_mov_b32 s18, 0
bg_pollE_ok:
    v_mov_b32 v68, v132
    v_mov_b32 v69, v133
    v_fma_f32 v46, -v43, v69, v128
    v_fma_f32 v47, v43, v68, v129
    v_fma_f32 v68, v42, v68, v46
    v_fma_f32 v69, v42, v69, v47
    v_fma_f32 v46, -v43, v69, v124
    v_fma_f32 v47, v43, v68, v125
    v_fma_f32 v68, v42, v68, v46
    v_fma_f32 v69, v42, v69, v47
    v_fma_f32 v46, -v43, v69, v120
    v_fma_f32 v47, v43, v68, v121
    v_fma_f32 v68, v42, v68, v46
    v_fma_f32 v69, v42, v69, v47
    v_fma_f32 v46, -v43, v69, v116
    v_fma_f32 v47, v43, v68, v117
    v_fma_f32 v68, v42, v68, v46
    v_fma_f32 v69, v42, v69, v47
    v_fma_f32 v46, -v43, v69, v112
    v_fma_f32 v47, v43, v68, v113
    v_fma_f32 v68, v42, v68, v46
    v_fma_f32 v69, v42, v69, v47
    v_fma_f32 v46, -v43, v69, v108
    v_fma_f32 v47, v43, v68, v109
    v_fma_f32 v68, v42, v68, v46
    v_fma_f32 v69, v42, v69, v47
    v_fma_f32 v46, -v43, v69, v104
    v_fma_f32 v47, v43, v68, v105
    v_fma_f32 v68, v42, v68, v46
    v_fma_f32 v69, v42, v69, v47
    v_fma_f32 v46, -v43, v69, v100
    v_fma_f32 v47, v43, v68, v101
    v_fma_f32 v68, v42, v68, v46
    v_fma_f32 v69, v42, v69, v47
    v_fma_f32 v46, -v43, v69, v96
    v_fma_f32 v47, v43, v68, v97
    v_fma_f32 v68, v42, v68, v46
    v_fma_f32 v69, v42, v69, v47
    v_fma_f32 v46, -v43, v69, v92
    v_fma_f32 v47, v43, v68, v93
    v_fma_f32 v68, v42, v68, v46
    v_fma_f32 v69, v42, v69, v47
    v_fma_f32 v46, -v43, v69, v88
    v_fma_f32 v47, v43, v68, v89
    v_fma_f32 v68, v42, v68, v46
    v_fma_f32 v69, v42, v69, v47
    v_fma_f32 v46, -v43, v69, v84
    v_fma_f32 v47, v43, v68, v85
    v_fma_f32 v68, v42, v68, v46
    v_fma_f32 v69, v42, v69, v47
    v_fma_f32 v46, -v43, v69, v80
    v_fma_f32 v47, v43, v68, v81
    v_fma_f32 v68, v42, v68, v46
    v_fma_f32 v69, v42, v69, v47
    v_fma_f32 v46, -v43, v69, v76
    v_fma_f32 v47, v43, v68, v77
    v_fma_f32 v68, v42, v68, v46
    v_fma_f32 v69, v42, v69, v47
    v_fma_f32 v46, -v43, v69, v72
    v_fma_f32 v47, v43, v68, v73
    v_fma_f32 v68, v42, v68, v46
    v_fma_f32 v69, v42, v69, v47
    v_mov_b32 v70, v68
    v_mov_b32 v71, v69
    v_mov_b32 v72, v68
    v_mov_b32 v73, v69
    s_nop 1
    v_permlane32_swap_b32 v70, v72
    v_permlane32_swap_b32 v71, v73
    v_fma_f32 v46, -v45, v73, v70
    v_fma_f32 v47, v45, v72, v71
    v_fma_f32 v72, v44, v72, v46
    v_fma_f32 v73, v44, v73, v47
    v_mov_b32 v74, v72
    v_mov_b32 v75, v73
    v_fma_f32 v46, -v41, v75, v56
    v_fma_f32 v47, v41, v74, v57
    v_fma_f32 v74, v40, v74, v46
    v_fma_f32 v75, v40, v75, v47
    v_cmp_lt_u32 vcc, 0, v51
    s_nop 1
    v_cndmask_b32 v72, v72, v74, vcc
    v_cndmask_b32 v73, v73, v75, vcc
    v_mov_b32 v74, v72
    v_mov_b32 v75, v73
    v_fma_f32 v46, -v41, v75, v58
    v_fma_f32 v47, v41, v74, v59
    v_fma_f32 v74, v40, v74, v46
    v_fma_f32 v75, v40, v75, v47
    v_cmp_lt_u32 vcc, 1, v51
    s_nop 1
    v_cndmask_b32 v72, v72, v74, vcc
    v_cndmask_b32 v73, v73, v75, vcc
    v_mov_b32 v74, v72
    v_mov_b32 v75, v73
    v_fma_f32 v46, -v41, v75, v60
    v_fma_f32 v47, v41, v74, v61
    v_fma_f32 v74, v40, v74, v46
    v_fma_f32 v75, v40, v75, v47
    v_cmp_lt_u32 vcc, 2, v51
    s_nop 1
    v_cndmask_b32 v72, v72, v74, vcc
    v_cndmask_b32 v73, v73, v75, vcc
    v_mov_b32 v66, 163584
bg_qd:
    ds_read_b32 v67, v66 offset:96
    s_waitcnt lgkmcnt(0)
    v_readfirstlane_b32 s3, v67
    s_cmp_ge_u32 s3, 4
    s_cbranch_scc1 bg_qd_ok
    s_sleep 1
    s_sub_u32 s18, s18, 1
    s_cbranch_scc0 bg_qd
    s_mov_b32 s18, 0
bg_qd_ok:
    s_lshl_b32 s3, s23, 12
    s_add_u32 s3, s3, 90112
    v_and_b32 v66, 31, v0
    v_lshlrev_b32 v66, 1, v66
    v_lshrrev_b32 v67, 5, v0
    v_lshl_add_u32 v66, v67, 8, v66
    v_add_u32 v66, s3, v66
    v_fma_f32 v46, -v3, v73, v8
    v_fma_f32 v47, v3, v72, v24
    v_fma_f32 v72, v2, v72, v46
    v_fma_f32 v73, v2, v73, v47
    v_cvt_pk_bf16_f32 v76, v72, -v73
    ds_write_b16 v66, v76 offset:0
    ds_write_b16_d16_hi v66, v76 offset:2048
    v_fma_f32 v46, -v3, v73, v9
    v_fma_f32 v47, v3, v72, v25
    v_fma_f32 v72, v2, v72, v46
    v_fma_f32 v73, v2, v73, v47
    v_cvt_pk_bf16_f32 v77, v72, -v73
    ds_write_b16 v66, v77 offset:64
    ds_write_b16_d16_hi v66, v77 offset:2112
    v_fma_f32 v46, -v3, v73, v10
    v_fma_f32 v47, v3, v72, v26
    v_fma_f32 v72, v2, v72, v46
    v_fma_f32 v73, v2, v73, v47
    v_cvt_pk_bf16_f32 v76, v72, -v73
    ds_write_b16 v66, v76 offset:128
    ds_write_b16_d16_hi v66, v76 offset:2176
    v_fma_f32 v46, -v3, v73, v11
    v_fma_f32 v47, v3, v72, v27
    v_fma_f32 v72, v2, v72, v46
    v_fma_f32 v73, v2, v73, v47
    v_cvt_pk_bf16_f32 v77, v72, -v73
    ds_write_b16 v66, v77 offset:192
    ds_write_b16_d16_hi v66, v77 offset:2240
    v_fma_f32 v46, -v3, v73, v12
    v_fma_f32 v47, v3, v72, v28
    v_fma_f32 v72, v2, v72, v46
    v_fma_f32 v73, v2, v73, v47
    v_cvt_pk_bf16_f32 v76, v72, -v73
    ds_write_b16 v66, v76 offset:512
    ds_write_b16_d16_hi v66, v76 offset:2560
    v_fma_f32 v46, -v3, v73, v13
    v_fma_f32 v47, v3, v72, v29
    v_fma_f32 v72, v2, v72, v46
    v_fma_f32 v73, v2, v73, v47
    v_cvt_pk_bf16_f32 v77, v72, -v73
    ds_write_b16 v66, v77 offset:576
    ds_write_b16_d16_hi v66, v77 offset:2624
    v_fma_f32 v46, -v3, v73, v14
    v_fma_f32 v47, v3, v72, v30
    v_fma_f32 v72, v2, v72, v46
    v_fma_f32 v73, v2, v73, v47
    v_cvt_pk_bf16_f32 v76, v72, -v73
    ds_write_b16 v66, v76 offset:640
    ds_write_b16_d16_hi v66, v76 offset:2688
    v_fma_f32 v46, -v3, v73, v15
    v_fma_f32 v47, v3, v72, v31
    v_fma_f32 v72, v2, v72, v46
    v_fma_f32 v73, v2, v73, v47
    v_cvt_pk_bf16_f32 v77, v72, -v73
    ds_write_b16 v66, v77 offset:704
    ds_write_b16_d16_hi v66, v77 offset:2752
    v_fma_f32 v46, -v3, v73, v16
    v_fma_f32 v47, v3, v72, v32
    v_fma_f32 v72, v2, v72, v46
    v_fma_f32 v73, v2, v73, v47
    v_cvt_pk_bf16_f32 v76, v72, -v73
    ds_write_b16 v66, v76 offset:1024
    ds_write_b16_d16_hi v66, v76 offset:3072
    v_fma_f32 v46, -v3, v73, v17
    v_fma_f32 v47, v3, v72, v33
    v_fma_f32 v72, v2, v72, v46
    v_fma_f32 v73, v2, v73, v47
    v_cvt_pk_bf16_f32 v77, v72, -v73
    ds_write_b16 v66, v77 offset:1088
    ds_write_b16_d16_hi v66, v77 offset:3136
    v_fma_f32 v46, -v3, v73, v18
    v_fma_f32 v47, v3, v72, v34
    v_fma_f32 v72, v2, v72, v46
    v_fma_f32 v73, v2, v73, v47
    v_cvt_pk_bf16_f32 v76, v72, -v73
    ds_write_b16 v66, v76 offset:1152
    ds_write_b16_d16_hi v66, v76 offset:3200
    v_fma_f32 v46, -v3, v73, v19
    v_fma_f32 v47, v3, v72, v35
    v_fma_f32 v72, v2, v72, v46
    v_fma_f32 v73, v2, v73, v47
    v_cvt_pk_bf16_f32 v77, v72, -v73
    ds_write_b16 v66, v77 offset:1216
    ds_write_b16_d16_hi v66, v77 offset:3264
    v_fma_f32 v46, -v3, v73, v20
    v_fma_f32 v47, v3, v72, v36
    v_fma_f32 v72, v2, v72, v46
    v_fma_f32 v73, v2, v73, v47
    v_cvt_pk_bf16_f32 v76, v72, -v73
    ds_write_b16 v66, v76 offset:1536
    ds_write_b16_d16_hi v66, v76 offset:3584
    v_fma_f32 v46, -v3, v73, v21
    v_fma_f32 v47, v3, v72, v37
    v_fma_f32 v72, v2, v72, v46
    v_fma_f32 v73, v2, v73, v47
    v_cvt_pk_bf16_f32 v77, v72, -v73
    ds_write_b16 v66, v77 offset:1600
    ds_write_b16_d16_hi v66, v77 offset:3648
    v_fma_f32 v46, -v3, v73, v22
    v_fma_f32 v47, v3, v72, v38
    v_fma_f32 v72, v2, v72, v46
    v_fma_f32 v73, v2, v73, v47
    v_cvt_pk_bf16_f32 v76, v72, -v73
    ds_write_b16 v66, v76 offset:1664
    ds_write_b16_d16_hi v66, v76 offset:3712
    v_fma_f32 v46, -v3, v73, v23
    v_fma_f32 v47, v3, v72, v39
    v_fma_f32 v72, v2, v72, v46
    v_fma_f32 v73, v2, v73, v47
    v_cvt_pk_bf16_f32 v77, v72, -v73
    ds_write_b16 v66, v77 offset:1728
    ds_write_b16_d16_hi v66, v77 offset:3776
    v_and_b32 v67, 31, v0
    v_lshlrev_b32 v67, 6, v67
    v_lshrrev_b32 v68, 5, v0
    v_lshl_add_u32 v67, v68, 4, v67
    v_add_u32 v67, s3, v67
    s_waitcnt lgkmcnt(0)
    ds_read_b128 v[80:83], v67 offset:0
    ds_read_b128 v[84:87], v67 offset:32
    ds_read_b128 v[88:91], v67 offset:2048
    ds_read_b128 v[92:95], v67 offset:2080
    s_lshl_b32 s3, s20, 1
    s_add_u32 s3, s3, s38
    s_mul_i32 s3, s3, 56
    s_lshl_b32 s33, s37, 1
    s_add_u32 s3, s3, s33
    s_lshl_b32 s3, s3, 10
    s_add_u32 s3, s3, 2621440
    s_add_u32 s33, s3, 28672
    s_waitcnt lgkmcnt(0)
    buffer_store_dwordx4 v[80:83], v1, s[24:27], s3 offen sc1
    buffer_store_dwordx4 v[84:87], v1, s[24:27], s3 offen offset:1024 sc1
    buffer_store_dwordx4 v[88:91], v1, s[24:27], s33 offen sc1
    buffer_store_dwordx4 v[92:95], v1, s[24:27], s33 offen offset:1024 sc1
    s_lshl_b32 s3, s20, 5
    s_add_u32 s3, s3, s21
    s_lshl_b32 s3, s3, 2
    s_add_u32 s3, s3, 270336
    v_mov_b32 v66, 163584
    v_mov_b32 v67, 1
    s_waitcnt vmcnt(0)
    s_mov_b64 exec, 1
    ds_add_rtn_u32 v67, v66, v67 offset:20
    s_waitcnt lgkmcnt(0)
    v_readfirstlane_b32 s60, v67
    s_mov_b64 exec, -1
    s_cmp_eq_u32 s60, 3
    s_cbranch_scc0 bg_hflag
    s_mov_b64 exec, 1
    v_mov_b32 v66, s19
    v_mov_b32 v67, 0
    buffer_store_dword v66, v67, s[24:27], s3 offen sc1
    s_mov_b64 exec, -1
bg_hflag:
    v_mov_b32 v66, 163584
bg_hall:
    ds_read_b32 v67, v66 offset:20
    s_waitcnt lgkmcnt(0)
    v_readfirstlane_b32 s3, v67
    s_cmp_ge_u32 s3, 4
    s_cbranch_scc1 bg_hall_ok
    s_sleep 1
    s_sub_u32 s18, s18, 1
    s_cbranch_scc0 bg_hall
    s_mov_b32 s18, 0
bg_hall_ok:
    s_setprio 0
    s_cmp_eq_u32 s23, 3
    s_cbranch_scc1 bg_not3c
    s_cmp_eq_u32 s23, 0
    s_cselect_b32 s56, s84, s86
    s_cselect_b32 s57, s85, s87
    s_cmp_eq_u32 s23, 2
    s_cselect_b32 s56, s72, s56
    s_cselect_b32 s57, s73, s57
    s_mov_b32 s48, s56
    s_mov_b32 s49, s57
    s_mov_b32 s50, 0x62000
    s_mov_b32 s51, 0x00020000
    s_lshr_b32 s3, s2, 3
    s_mul_i32 s3, s3, 12544
    v_lshlrev_b32 v158, 7, v0
    s_mov_b32 m0, 161792
    s_nop 0
    buffer_load_dword v158, s[48:51], s3 offen lds
    s_add_u32 s3, s3, 8192
    s_mov_b32 exec_hi, 3
    buffer_load_dword v158, s[48:51], s3 offen lds
    s_mov_b64 exec, -1
bg_not3c:
    s_lshr_b32 s3, s23, 1
    s_cmp_eq_u32 s3, 0
    s_cselect_b32 s28, s84, s86
    s_cselect_b32 s29, s85, s87
    v_lshrrev_b32 v69, 4, v0
    v_and_b32 v53, 3, v0
    v_xor_b32 v53, v53, v69
    v_lshlrev_b32 v53, 4, v53
    v_lshrrev_b32 v69, 2, v0
    v_mul_u32_u24 v69, 896, v69
    v_add_u32 v53, v53, v69
    s_mul_i32 s40, s21, 57344
    s_and_b32 s3, s23, 1
    s_mul_i32 s3, s3, 448
    s_add_u32 s40, s40, s3
    s_mul_i32 s41, s23, 20480
    s_add_u32 m0, s41, 0
    s_add_u32 s33, s40, 0
    buffer_load_dwordx4 v53, s[28:31], s33 offen lds
    s_add_u32 m0, m0, 1024
    s_add_u32 s33, s40, 14336
    buffer_load_dwordx4 v53, s[28:31], s33 offen lds
    s_add_u32 m0, m0, 1024
    s_add_u32 s33, s40, 28672
    buffer_load_dwordx4 v53, s[28:31], s33 offen lds
    s_add_u32 m0, m0, 1024
    s_add_u32 s33, s40, 43008
    buffer_load_dwordx4 v53, s[28:31], s33 offen lds
    s_add_u32 m0, s41, 4096
    s_add_u32 s33, s40, 64
    buffer_load_dwordx4 v53, s[28:31], s33 offen lds
    s_add_u32 m0, m0, 1024
    s_add_u32 s33, s40, 14400
    buffer_load_dwordx4 v53, s[28:31], s33 offen lds
    s_add_u32 m0, m0, 1024
    s_add_u32 s33, s40, 28736
    buffer_load_dwordx4 v53, s[28:31], s33 offen lds
    s_add_u32 m0, m0, 1024
    s_add_u32 s33, s40, 43072
    buffer_load_dwordx4 v53, s[28:31], s33 offen lds
    s_add_u32 m0, s41, 8192
    s_add_u32 s33, s40, 128
    buffer_load_dwordx4 v53, s[28:31], s33 offen lds
    s_add_u32 m0, m0, 1024
    s_add_u32 s33, s40, 14464
    buffer_load_dwordx4 v53, s[28:31], s33 offen lds
    s_add_u32 m0, m0, 1024
    s_add_u32 s33, s40, 28800
    buffer_load_dwordx4 v53, s[28:31], s33 offen lds
    s_add_u32 m0, m0, 1024
    s_add_u32 s33, s40, 43136
    buffer_load_dwordx4 v53, s[28:31], s33 offen lds
    s_add_u32 m0, s41, 12288
    s_add_u32 s33, s40, 192
    buffer_load_dwordx4 v53, s[28:31], s33 offen lds
    s_add_u32 m0, m0, 1024
    s_add_u32 s33, s40, 14528
    buffer_load_dwordx4 v53, s[28:31], s33 offen lds
    s_add_u32 m0, m0, 1024
    s_add_u32 s33, s40, 28864
    buffer_load_dwordx4 v53, s[28:31], s33 offen lds
    s_add_u32 m0, m0, 1024
    s_add_u32 s33, s40, 43200
    buffer_load_dwordx4 v53, s[28:31], s33 offen lds
    s_add_u32 m0, s41, 16384
    s_add_u32 s33, s40, 256
    buffer_load_dwordx4 v53, s[28:31], s33 offen lds
    s_add_u32 m0, m0, 1024
    s_add_u32 s33, s40, 14592
    buffer_load_dwordx4 v53, s[28:31], s33 offen lds
    s_add_u32 m0, m0, 1024
    s_add_u32 s33, s40, 28928
    buffer_load_dwordx4 v53, s[28:31], s33 offen lds
    s_add_u32 m0, m0, 1024
    s_add_u32 s33, s40, 43264
    buffer_load_dwordx4 v53, s[28:31], s33 offen lds
    s_setprio 3
    s_cmp_eq_u32 s23, 0
    s_cbranch_scc0 bg_nopollH2
    v_lshlrev_b32 v67, 2, v0
    s_lshl_b32 s35, s20, 7
    s_add_u32 s35, s35, 270336
    s_mov_b64 s[58:59], 0x7f
bg_pollH:
    buffer_load_dword v68, v67, s[24:27], s35 offen sc1
    s_waitcnt vmcnt(0)
    v_cmp_ne_u32 vcc, s19, v68
    s_and_b64 vcc, vcc, s[58:59]
    s_cbranch_vccz bg_pollH_ok
    s_sleep 8
    s_sub_u32 s18, s18, 1
    s_cbranch_scc0 bg_pollH
    s_mov_b32 s18, 0
bg_pollH_ok:
    s_branch bg_pollG_ok
bg_nopollH2:
    s_cmp_eq_u32 s23, 1
    s_cbranch_scc0 bg_pollG_ok
    s_mov_b32 s48, s96
    s_mov_b32 s49, s97
    s_mov_b32 s50, 0x100
    s_mov_b32 s51, 0x00020000
    v_mov_b32 v67, 144
bg_pollG:
    buffer_load_dword v68, v67, s[48:51], 0 offen sc1
    s_waitcnt vmcnt(0)
    v_readfirstlane_b32 s3, v68
    s_cmp_lg_u32 s3, 0
    s_cbranch_scc1 bg_pollG_ok
    s_sleep 8
    s_sub_u32 s18, s18, 1
    s_cbranch_scc0 bg_pollG
    s_mov_b32 s18, 0
bg_pollG_ok:
bg_nopollH:
    s_waitcnt vmcnt(0)
    v_mov_b32 v54, 163584
    s_add_u32 s44, s44, 4
    v_mov_b32 v55, 1
    s_waitcnt lgkmcnt(0)
    s_mov_b64 exec, 1
    ds_add_u32 v54, v55 offset:4
    s_mov_b64 exec, -1
bg_bar4:
    ds_read_b32 v55, v54 offset:4
    s_waitcnt lgkmcnt(0)
    v_readfirstlane_b32 s3, v55
    s_cmp_ge_u32 s3, s44
    s_cbranch_scc1 bg_bar4_ok
    s_sleep 1
    s_sub_u32 s18, s18, 1
    s_cbranch_scc0 bg_bar4
    s_mov_b32 s18, 0
bg_bar4_ok:
    s_setprio 0
    s_lshl_b32 s3, s20, 1
    s_mul_i32 s3, s3, 56
    s_mul_i32 s33, s23, 14
    s_add_u32 s3, s3, s33
    s_lshl_b32 s3, s3, 10
    s_add_u32 s32, s3, 2621440
    s_add_u32 s34, s32, 57344
    v_lshrrev_b32 v72, 4, v0
    v_and_b32 v2, 3, v0
    v_xor_b32 v2, v2, v72
    v_lshlrev_b32 v2, 4, v2
    v_lshrrev_b32 v72, 2, v0
    v_mul_u32_u24 v72, 896, v72
    v_add_u32 v2, v2, v72
    v_bfe_u32 v72, v0, 2, 2
    v_lshrrev_b32 v6, 5, v0
    v_xor_b32 v72, v72, v6
    v_lshlrev_b32 v72, 4, v72
    v_and_b32 v6, 31, v0
    v_lshl_add_u32 v6, v6, 6, v72
    v_add_u32 v6, s41, v6
    v_xor_b32 v7, 32, v6
    s_add_u32 s35, s32, 0
    s_add_u32 s36, s34, 0
    buffer_load_dwordx4 v[88:91], v1, s[24:27], s35 offen sc1
    buffer_load_dwordx4 v[92:95], v1, s[24:27], s36 offen sc1
    s_add_u32 s35, s32, 1024
    s_add_u32 s36, s34, 1024
    buffer_load_dwordx4 v[96:99], v1, s[24:27], s35 offen sc1
    buffer_load_dwordx4 v[100:103], v1, s[24:27], s36 offen sc1
    s_add_u32 s35, s32, 2048
    s_add_u32 s36, s34, 2048
    buffer_load_dwordx4 v[104:107], v1, s[24:27], s35 offen sc1
    buffer_load_dwordx4 v[108:111], v1, s[24:27], s36 offen sc1
    s_add_u32 s35, s32, 3072
    s_add_u32 s36, s34, 3072
    buffer_load_dwordx4 v[112:115], v1, s[24:27], s35 offen sc1
    buffer_load_dwordx4 v[116:119], v1, s[24:27], s36 offen sc1
    s_add_u32 s35, s32, 4096
    s_add_u32 s36, s34, 4096
    buffer_load_dwordx4 v[120:123], v1, s[24:27], s35 offen sc1
    buffer_load_dwordx4 v[124:127], v1, s[24:27], s36 offen sc1
    s_add_u32 s35, s32, 5120
    s_add_u32 s36, s34, 5120
    buffer_load_dwordx4 v[128:131], v1, s[24:27], s35 offen sc1
    buffer_load_dwordx4 v[132:135], v1, s[24:27], s36 offen sc1
    s_add_u32 s35, s32, 6144
    s_add_u32 s36, s34, 6144
    buffer_load_dwordx4 v[136:139], v1, s[24:27], s35 offen sc1
    buffer_load_dwordx4 v[140:143], v1, s[24:27], s36 offen sc1
    s_add_u32 s35, s32, 7168
    s_add_u32 s36, s34, 7168
    buffer_load_dwordx4 v[144:147], v1, s[24:27], s35 offen sc1
    buffer_load_dwordx4 v[148:151], v1, s[24:27], s36 offen sc1
    s_add_u32 s35, s32, 8192
    s_add_u32 s36, s34, 8192
    buffer_load_dwordx4 v[152:155], v1, s[24:27], s35 offen sc1
    buffer_load_dwordx4 v[156:159], v1, s[24:27], s36 offen sc1
    s_add_u32 s35, s32, 9216
    s_add_u32 s36, s34, 9216
    buffer_load_dwordx4 v[160:163], v1, s[24:27], s35 offen sc1
    buffer_load_dwordx4 v[164:167], v1, s[24:27], s36 offen sc1
    v_lshlrev_b32 v72, 7, v0
    s_mov_b32 m0, 161792
    s_add_u32 s35, s32, 10240
    s_add_u32 s36, s34, 10240
    s_mov_b32 exec_hi, 0
    buffer_load_dword v72, s[24:27], s35 offen sc1 lds
    buffer_load_dword v72, s[24:27], s36 offen sc1 lds
    s_mov_b64 exec, -1
    ds_read_b128 v[72:75], v6 offset:0
    ds_read_b128 v[76:79], v6 offset:2048
    s_waitcnt vmcnt(20)
    ds_read_b128 v[80:83], v7 offset:0
    ds_read_b128 v[84:87], v7 offset:2048
    s_waitcnt lgkmcnt(2)
    v_mfma_f32_32x32x16_bf16 v[8:23], v[88:91], v[72:75], 0
    v_mfma_f32_32x32x16_bf16 v[24:39], v[88:91], v[76:79], 0
    v_mfma_f32_32x32x16_bf16 v[40:55], v[92:95], v[72:75], 0
    v_mfma_f32_32x32x16_bf16 v[56:71], v[92:95], v[76:79], 0
    s_add_u32 s35, s32, 10240
    s_add_u32 s36, s34, 10240
    buffer_load_dwordx4 v[88:91], v1, s[24:27], s35 offen sc1
    buffer_load_dwordx4 v[92:95], v1, s[24:27], s36 offen sc1
    s_waitcnt vmcnt(20)
    ds_read_b128 v[72:75], v6 offset:4096
    ds_read_b128 v[76:79], v6 offset:6144
    s_waitcnt lgkmcnt(2)
    v_mfma_f32_32x32x16_bf16 v[8:23], v[96:99], v[80:83], v[8:23]
    v_mfma_f32_32x32x16_bf16 v[24:39], v[96:99], v[84:87], v[24:39]
    v_mfma_f32_32x32x16_bf16 v[40:55], v[100:103], v[80:83], v[40:55]
    v_mfma_f32_32x32x16_bf16 v[56:71], v[100:103], v[84:87], v[56:71]
    s_add_u32 s35, s32, 11264
    s_add_u32 s36, s34, 11264
    buffer_load_dwordx4 v[96:99], v1, s[24:27], s35 offen sc1
    buffer_load_dwordx4 v[100:103], v1, s[24:27], s36 offen sc1
    s_add_u32 m0, s41, 0
    s_add_u32 s33, s40, 320
    buffer_load_dwordx4 v2, s[28:31], s33 offen lds
    s_add_u32 m0, m0, 1024
    s_add_u32 s33, s40, 14656
    buffer_load_dwordx4 v2, s[28:31], s33 offen lds
    s_add_u32 m0, m0, 1024
    s_add_u32 s33, s40, 28992
    buffer_load_dwordx4 v2, s[28:31], s33 offen lds
    s_add_u32 m0, m0, 1024
    s_add_u32 s33, s40, 43328
    buffer_load_dwordx4 v2, s[28:31], s33 offen lds
    s_waitcnt vmcnt(24)
    ds_read_b128 v[80:83], v7 offset:4096
    ds_read_b128 v[84:87], v7 offset:6144
    s_waitcnt lgkmcnt(2)
    v_mfma_f32_32x32x16_bf16 v[8:23], v[104:107], v[72:75], v[8:23]
    v_mfma_f32_32x32x16_bf16 v[24:39], v[104:107], v[76:79], v[24:39]
    v_mfma_f32_32x32x16_bf16 v[40:55], v[108:111], v[72:75], v[40:55]
    v_mfma_f32_32x32x16_bf16 v[56:71], v[108:111], v[76:79], v[56:71]
    s_add_u32 s35, s32, 12288
    s_add_u32 s36, s34, 12288
    buffer_load_dwordx4 v[104:107], v1, s[24:27], s35 offen sc1
    buffer_load_dwordx4 v[108:111], v1, s[24:27], s36 offen sc1
    s_waitcnt vmcnt(24)
    ds_read_b128 v[72:75], v6 offset:8192
    ds_read_b128 v[76:79], v6 offset:10240
    s_waitcnt lgkmcnt(2)
    v_mfma_f32_32x32x16_bf16 v[8:23], v[112:115], v[80:83], v[8:23]
    v_mfma_f32_32x32x16_bf16 v[24:39], v[112:115], v[84:87], v[24:39]
    v_mfma_f32_32x32x16_bf16 v[40:55], v[116:119], v[80:83], v[40:55]
    v_mfma_f32_32x32x16_bf16 v[56:71], v[116:119], v[84:87], v[56:71]
    s_add_u32 s35, s32, 13312
    s_add_u32 s36, s34, 13312
    buffer_load_dwordx4 v[112:115], v1, s[24:27], s35 offen sc1
    buffer_load_dwordx4 v[116:119], v1, s[24:27], s36 offen sc1
    s_add_u32 m0, s41, 4096
    s_add_u32 s33, s40, 384
    buffer_load_dwordx4 v2, s[28:31], s33 offen lds
    s_add_u32 m0, m0, 1024
    s_add_u32 s33, s40, 14720
    buffer_load_dwordx4 v2, s[28:31], s33 offen lds
    s_add_u32 m0, m0, 1024
    s_add_u32 s33, s40, 29056
    buffer_load_dwordx4 v2, s[28:31], s33 offen lds
    s_add_u32 m0, m0, 1024
    s_add_u32 s33, s40, 43392
    buffer_load_dwordx4 v2, s[28:31], s33 offen lds
    s_waitcnt vmcnt(28)
    ds_read_b128 v[80:83], v7 offset:8192
    ds_read_b128 v[84:87], v7 offset:10240
    s_waitcnt lgkmcnt(2)
    v_mfma_f32_32x32x16_bf16 v[8:23], v[120:123], v[72:75], v[8:23]
    v_mfma_f32_32x32x16_bf16 v[24:39], v[120:123], v[76:79], v[24:39]
    v_mfma_f32_32x32x16_bf16 v[40:55], v[124:127], v[72:75], v[40:55]
    v_mfma_f32_32x32x16_bf16 v[56:71], v[124:127], v[76:79], v[56:71]
    s_waitcnt vmcnt(26)
    ds_read_b128 v[72:75], v6 offset:12288
    ds_read_b128 v[76:79], v6 offset:14336
    s_waitcnt lgkmcnt(2)
    v_mfma_f32_32x32x16_bf16 v[8:23], v[128:131], v[80:83], v[8:23]
    v_mfma_f32_32x32x16_bf16 v[24:39], v[128:131], v[84:87], v[24:39]
    v_mfma_f32_32x32x16_bf16 v[40:55], v[132:135], v[80:83], v[40:55]
    v_mfma_f32_32x32x16_bf16 v[56:71], v[132:135], v[84:87], v[56:71]
    s_waitcnt vmcnt(24)
    ds_read_b128 v[80:83], v7 offset:12288
    ds_read_b128 v[84:87], v7 offset:14336
    s_waitcnt lgkmcnt(2)
    v_mfma_f32_32x32x16_bf16 v[8:23], v[136:139], v[72:75], v[8:23]
    v_mfma_f32_32x32x16_bf16 v[24:39], v[136:139], v[76:79], v[24:39]
    v_mfma_f32_32x32x16_bf16 v[40:55], v[140:143], v[72:75], v[40:55]
    v_mfma_f32_32x32x16_bf16 v[56:71], v[140:143], v[76:79], v[56:71]
    s_waitcnt vmcnt(22)
    ds_read_b128 v[72:75], v6 offset:16384
    ds_read_b128 v[76:79], v6 offset:18432
    s_waitcnt lgkmcnt(2)
    v_mfma_f32_32x32x16_bf16 v[8:23], v[144:147], v[80:83], v[8:23]
    v_mfma_f32_32x32x16_bf16 v[24:39], v[144:147], v[84:87], v[24:39]
    v_mfma_f32_32x32x16_bf16 v[40:55], v[148:151], v[80:83], v[40:55]
    v_mfma_f32_32x32x16_bf16 v[56:71], v[148:151], v[84:87], v[56:71]
    s_waitcnt vmcnt(20)
    ds_read_b128 v[80:83], v7 offset:16384
    ds_read_b128 v[84:87], v7 offset:18432
    s_waitcnt lgkmcnt(2)
    v_mfma_f32_32x32x16_bf16 v[8:23], v[152:155], v[72:75], v[8:23]
    v_mfma_f32_32x32x16_bf16 v[24:39], v[152:155], v[76:79], v[24:39]
    v_mfma_f32_32x32x16_bf16 v[40:55], v[156:159], v[72:75], v[40:55]
    v_mfma_f32_32x32x16_bf16 v[56:71], v[156:159], v[76:79], v[56:71]
    s_waitcnt vmcnt(8)
    ds_read_b128 v[72:75], v6 offset:0
    ds_read_b128 v[76:79], v6 offset:2048
    s_waitcnt lgkmcnt(2)
    v_mfma_f32_32x32x16_bf16 v[8:23], v[160:163], v[80:83], v[8:23]
    v_mfma_f32_32x32x16_bf16 v[24:39], v[160:163], v[84:87], v[24:39]
    v_mfma_f32_32x32x16_bf16 v[40:55], v[164:167], v[80:83], v[40:55]
    v_mfma_f32_32x32x16_bf16 v[56:71], v[164:167], v[84:87], v[56:71]
    s_waitcnt vmcnt(8)
    ds_read_b128 v[80:83], v7 offset:0
    ds_read_b128 v[84:87], v7 offset:2048
    s_waitcnt lgkmcnt(2)
    v_mfma_f32_32x32x16_bf16 v[8:23], v[88:91], v[72:75], v[8:23]
    v_mfma_f32_32x32x16_bf16 v[24:39], v[88:91], v[76:79], v[24:39]
    v_mfma_f32_32x32x16_bf16 v[40:55], v[92:95], v[72:75], v[40:55]
    v_mfma_f32_32x32x16_bf16 v[56:71], v[92:95], v[76:79], v[56:71]
    s_waitcnt vmcnt(0)
    ds_read_b128 v[72:75], v6 offset:4096
    ds_read_b128 v[76:79], v6 offset:6144
    s_waitcnt lgkmcnt(2)
    v_mfma_f32_32x32x16_bf16 v[8:23], v[96:99], v[80:83], v[8:23]
    v_mfma_f32_32x32x16_bf16 v[24:39], v[96:99], v[84:87], v[24:39]
    v_mfma_f32_32x32x16_bf16 v[40:55], v[100:103], v[80:83], v[40:55]
    v_mfma_f32_32x32x16_bf16 v[56:71], v[100:103], v[84:87], v[56:71]
    s_waitcnt vmcnt(0)
    ds_read_b128 v[80:83], v7 offset:4096
    ds_read_b128 v[84:87], v7 offset:6144
    s_waitcnt lgkmcnt(2)
    v_mfma_f32_32x32x16_bf16 v[8:23], v[104:107], v[72:75], v[8:23]
    v_mfma_f32_32x32x16_bf16 v[24:39], v[104:107], v[76:79], v[24:39]
    v_mfma_f32_32x32x16_bf16 v[40:55], v[108:111], v[72:75], v[40:55]
    v_mfma_f32_32x32x16_bf16 v[56:71], v[108:111], v[76:79], v[56:71]
    s_waitcnt vmcnt(4)
    s_waitcnt lgkmcnt(0)
    v_mfma_f32_32x32x16_bf16 v[8:23], v[112:115], v[80:83], v[8:23]
    v_mfma_f32_32x32x16_bf16 v[24:39], v[112:115], v[84:87], v[24:39]
    v_mfma_f32_32x32x16_bf16 v[40:55], v[116:119], v[80:83], v[40:55]
    v_mfma_f32_32x32x16_bf16 v[56:71], v[116:119], v[84:87], v[56:71]
    s_lshl_b32 s3, s20, 6
    s_lshl_b32 s33, s38, 5
    s_add_u32 s3, s3, s33
    v_lshrrev_b32 v80, 5, v0
    v_lshlrev_b32 v80, 4, v80
    v_add_u32 v80, s3, v80
    s_lshl_b32 s33, s21, 6
    s_and_b32 s35, s23, 1
    s_lshl_b32 s35, s35, 5
    s_add_u32 s33, s33, s35
    v_and_b32 v81, 31, v0
    v_add_u32 v81, s33, v81
    s_mov_b32 s48, s64
    s_mov_b32 s49, s65
    s_mov_b32 s50, 0x1c0000
    s_mov_b32 s51, 0x00020000
    v_mul_u32_u24 v82, 896, v80
    v_lshl_add_u32 v82, v81, 1, v82
    buffer_load_ushort v136, v82, s[48:51], 0 offen offset:0
    buffer_load_ushort v137, v82, s[48:51], 0 offen offset:896
    buffer_load_ushort v138, v82, s[48:51], 0 offen offset:1792
    buffer_load_ushort v139, v82, s[48:51], 0 offen offset:2688
    v_add_u32 v82, 3584, v82
    buffer_load_ushort v140, v82, s[48:51], 0 offen offset:0
    buffer_load_ushort v141, v82, s[48:51], 0 offen offset:896
    buffer_load_ushort v142, v82, s[48:51], 0 offen offset:1792
    buffer_load_ushort v143, v82, s[48:51], 0 offen offset:2688
    v_add_u32 v82, 3584, v82
    buffer_load_ushort v144, v82, s[48:51], 0 offen offset:0
    buffer_load_ushort v145, v82, s[48:51], 0 offen offset:896
    buffer_load_ushort v146, v82, s[48:51], 0 offen offset:1792
    buffer_load_ushort v147, v82, s[48:51], 0 offen offset:2688
    v_add_u32 v82, 3584, v82
    buffer_load_ushort v148, v82, s[48:51], 0 offen offset:0
    buffer_load_ushort v149, v82, s[48:51], 0 offen offset:896
    buffer_load_ushort v150, v82, s[48:51], 0 offen offset:1792
    buffer_load_ushort v151, v82, s[48:51], 0 offen offset:2688
    s_mov_b32 s52, s90
    s_mov_b32 s53, s91
    s_mov_b32 s54, 0x380
    s_mov_b32 s55, 0x00020000
    v_lshlrev_b32 v83, 1, v81
    buffer_load_ushort v3, v83, s[52:55], 0 offen
    v_lshlrev_b32 v83, 2, v80
    s_mov_b32 s35, 262144
    buffer_load_dwordx4 v[152:155], v83, s[24:27], s35 offen offset:0 sc1
    buffer_load_dwordx4 v[156:159], v83, s[24:27], s35 offen offset:16 sc1
    buffer_load_dwordx4 v[160:163], v83, s[24:27], s35 offen offset:32 sc1
    buffer_load_dwordx4 v[164:167], v83, s[24:27], s35 offen offset:48 sc1
    s_setprio 2
    v_mov_b32 v4, 163584
    s_add_u32 s44, s44, 4
    v_mov_b32 v5, 1
    s_waitcnt lgkmcnt(0)
    s_mov_b64 exec, 1
    ds_add_u32 v4, v5 offset:4
    s_mov_b64 exec, -1
bg_bar5:
    ds_read_b32 v5, v4 offset:4
    s_waitcnt lgkmcnt(0)
    v_readfirstlane_b32 s3, v5
    s_cmp_ge_u32 s3, s44
    s_cbranch_scc1 bg_bar5_ok
    s_sleep 1
    s_sub_u32 s18, s18, 1
    s_cbranch_scc0 bg_bar5
    s_mov_b32 s18, 0
bg_bar5_ok:
    v_mov_b32 v4, 163584
bg_trd:
    ds_read_b32 v5, v4 offset:44
    s_waitcnt lgkmcnt(0)
    v_readfirstlane_b32 s3, v5
    s_cmp_ge_u32 s3, 8
    s_cbranch_scc1 bg_trd_ok
    s_sleep 1
    s_sub_u32 s18, s18, 1
    s_cbranch_scc0 bg_trd
    s_mov_b32 s18, 0
bg_trd_ok:
    s_lshl_b32 s3, s23, 12
    s_add_u32 s3, s3, 90112
    v_add_u32 v75, s3, v1
    ds_write_b128 v75, v[8:11] offset:0
    ds_write_b128 v75, v[12:15] offset:1024
    ds_write_b128 v75, v[16:19] offset:2048
    ds_write_b128 v75, v[20:23] offset:3072
    ds_write_b128 v75, v[24:27] offset:16384
    ds_write_b128 v75, v[28:31] offset:17408
    ds_write_b128 v75, v[32:35] offset:18432
    ds_write_b128 v75, v[36:39] offset:19456
    ds_write_b128 v75, v[40:43] offset:32768
    ds_write_b128 v75, v[44:47] offset:33792
    ds_write_b128 v75, v[48:51] offset:34816
    ds_write_b128 v75, v[52:55] offset:35840
    ds_write_b128 v75, v[56:59] offset:49152
    ds_write_b128 v75, v[60:63] offset:50176
    ds_write_b128 v75, v[64:67] offset:51200
    ds_write_b128 v75, v[68:71] offset:52224
    v_mov_b32 v4, 163584
    s_add_u32 s44, s44, 4
    v_mov_b32 v5, 1
    s_waitcnt lgkmcnt(0)
    s_mov_b64 exec, 1
    ds_add_u32 v4, v5 offset:4
    s_mov_b64 exec, -1
bg_bar6:
    ds_read_b32 v5, v4 offset:4
    s_waitcnt lgkmcnt(0)
    v_readfirstlane_b32 s3, v5
    s_cmp_ge_u32 s3, s44
    s_cbranch_scc1 bg_bar6_ok
    s_sleep 1
    s_sub_u32 s18, s18, 1
    s_cbranch_scc0 bg_bar6
    s_mov_b32 s18, 0
bg_bar6_ok:
    s_lshl_b32 s3, s23, 14
    s_add_u32 s3, s3, 90112
    v_add_u32 v75, s3, v1
    ds_read_b128 v[88:91], v75 offset:0
    ds_read_b128 v[92:95], v75 offset:1024
    ds_read_b128 v[96:99], v75 offset:2048
    ds_read_b128 v[100:103], v75 offset:3072
    ds_read_b128 v[104:107], v75 offset:4096
    ds_read_b128 v[108:111], v75 offset:5120
    ds_read_b128 v[112:115], v75 offset:6144
    ds_read_b128 v[116:119], v75 offset:7168
    ds_read_b128 v[120:123], v75 offset:8192
    ds_read_b128 v[124:127], v75 offset:9216
    ds_read_b128 v[128:131], v75 offset:10240
    ds_read_b128 v[132:135], v75 offset:11264
    ds_read_b128 v[8:11], v75 offset:12288
    ds_read_b128 v[12:15], v75 offset:13312
    ds_read_b128 v[16:19], v75 offset:14336
    s_waitcnt lgkmcnt(4)
    ds_read_b128 v[20:23], v75 offset:15360
    s_waitcnt lgkmcnt(0)
    s_waitcnt vmcnt(0)
    v_add_f32 v88, v88, v104
    v_add_f32 v8, v8, v120
    v_add_f32 v89, v89, v105
    v_add_f32 v9, v9, v121
    v_add_f32 v90, v90, v106
    v_add_f32 v10, v10, v122
    v_add_f32 v91, v91, v107
    v_add_f32 v11, v11, v123
    v_add_f32 v92, v92, v108
    v_add_f32 v12, v12, v124
    v_add_f32 v93, v93, v109
    v_add_f32 v13, v13, v125
    v_add_f32 v94, v94, v110
    v_add_f32 v14, v14, v126
    v_add_f32 v95, v95, v111
    v_add_f32 v15, v15, v127
    v_add_f32 v96, v96, v112
    v_add_f32 v16, v16, v128
    v_add_f32 v97, v97, v113
    v_add_f32 v17, v17, v129
    v_add_f32 v98, v98, v114
    v_add_f32 v18, v18, v130
    v_add_f32 v99, v99, v115
    v_add_f32 v19, v19, v131
    v_add_f32 v100, v100, v116
    v_add_f32 v20, v20, v132
    v_add_f32 v101, v101, v117
    v_add_f32 v21, v21, v133
    v_add_f32 v102, v102, v118
    v_add_f32 v22, v22, v134
    v_add_f32 v103, v103, v119
    v_add_f32 v23, v23, v135
    v_lshlrev_b32 v3, 16, v3
    v_add_f32 v8, v8, v88
    v_lshlrev_b32 v136, 16, v136
    v_mul_f32 v136, v136, v3
    v_fma_f32 v8, 2.0, v8, v136
    v_sub_f32 v136, 1.0, v152
    v_mul_f32 v8, v8, v136
    v_add_f32 v9, v9, v89
    v_lshlrev_b32 v137, 16, v137
    v_mul_f32 v137, v137, v3
    v_fma_f32 v9, 2.0, v9, v137
    v_sub_f32 v137, 1.0, v153
    v_mul_f32 v9, v9, v137
    v_add_f32 v10, v10, v90
    v_lshlrev_b32 v138, 16, v138
    v_mul_f32 v138, v138, v3
    v_fma_f32 v10, 2.0, v10, v138
    v_sub_f32 v138, 1.0, v154
    v_mul_f32 v10, v10, v138
    v_add_f32 v11, v11, v91
    v_lshlrev_b32 v139, 16, v139
    v_mul_f32 v139, v139, v3
    v_fma_f32 v11, 2.0, v11, v139
    v_sub_f32 v139, 1.0, v155
    v_mul_f32 v11, v11, v139
    v_add_f32 v12, v12, v92
    v_lshlrev_b32 v140, 16, v140
    v_mul_f32 v140, v140, v3
    v_fma_f32 v12, 2.0, v12, v140
    v_sub_f32 v140, 1.0, v156
    v_mul_f32 v12, v12, v140
    v_add_f32 v13, v13, v93
    v_lshlrev_b32 v141, 16, v141
    v_mul_f32 v141, v141, v3
    v_fma_f32 v13, 2.0, v13, v141
    v_sub_f32 v141, 1.0, v157
    v_mul_f32 v13, v13, v141
    v_add_f32 v14, v14, v94
    v_lshlrev_b32 v142, 16, v142
    v_mul_f32 v142, v142, v3
    v_fma_f32 v14, 2.0, v14, v142
    v_sub_f32 v142, 1.0, v158
    v_mul_f32 v14, v14, v142
    v_add_f32 v15, v15, v95
    v_lshlrev_b32 v143, 16, v143
    v_mul_f32 v143, v143, v3
    v_fma_f32 v15, 2.0, v15, v143
    v_sub_f32 v143, 1.0, v159
    v_mul_f32 v15, v15, v143
    v_add_f32 v16, v16, v96
    v_lshlrev_b32 v144, 16, v144
    v_mul_f32 v144, v144, v3
    v_fma_f32 v16, 2.0, v16, v144
    v_sub_f32 v144, 1.0, v160
    v_mul_f32 v16, v16, v144
    v_add_f32 v17, v17, v97
    v_lshlrev_b32 v145, 16, v145
    v_mul_f32 v145, v145, v3
    v_fma_f32 v17, 2.0, v17, v145
    v_sub_f32 v145, 1.0, v161
    v_mul_f32 v17, v17, v145
    v_add_f32 v18, v18, v98
    v_lshlrev_b32 v146, 16, v146
    v_mul_f32 v146, v146, v3
    v_fma_f32 v18, 2.0, v18, v146
    v_sub_f32 v146, 1.0, v162
    v_mul_f32 v18, v18, v146
    v_add_f32 v19, v19, v99
    v_lshlrev_b32 v147, 16, v147
    v_mul_f32 v147, v147, v3
    v_fma_f32 v19, 2.0, v19, v147
    v_sub_f32 v147, 1.0, v163
    v_mul_f32 v19, v19, v147
    v_add_f32 v20, v20, v100
    v_lshlrev_b32 v148, 16, v148
    v_mul_f32 v148, v148, v3
    v_fma_f32 v20, 2.0, v20, v148
    v_sub_f32 v148, 1.0, v164
    v_mul_f32 v20, v20, v148
    v_add_f32 v21, v21, v101
    v_lshlrev_b32 v149, 16, v149
    v_mul_f32 v149, v149, v3
    v_fma_f32 v21, 2.0, v21, v149
    v_sub_f32 v149, 1.0, v165
    v_mul_f32 v21, v21, v149
    v_add_f32 v22, v22, v102
    v_lshlrev_b32 v150, 16, v150
    v_mul_f32 v150, v150, v3
    v_fma_f32 v22, 2.0, v22, v150
    v_sub_f32 v150, 1.0, v166
    v_mul_f32 v22, v22, v150
    v_add_f32 v23, v23, v103
    v_lshlrev_b32 v151, 16, v151
    v_mul_f32 v151, v151, v3
    v_fma_f32 v23, 2.0, v23, v151
    v_sub_f32 v151, 1.0, v167
    v_mul_f32 v23, v23, v151
    s_lshl_b32 s3, s20, 6
    s_lshl_b32 s33, s38, 5
    s_add_u32 s3, s3, s33
    v_lshrrev_b32 v40, 5, v0
    v_lshlrev_b32 v40, 4, v40
    v_add_u32 v40, s3, v40
    s_lshl_b32 s33, s21, 6
    s_and_b32 s35, s23, 1
    s_lshl_b32 s35, s35, 5
    s_add_u32 s33, s33, s35
    v_and_b32 v41, 31, v0
    v_add_u32 v41, s33, v41
    v_mul_u32_u24 v42, 1792, v40
    v_lshl_add_u32 v42, v41, 2, v42
    s_mov_b32 s48, s94
    s_mov_b32 s49, s95
    s_mov_b32 s50, 0x380000
    s_mov_b32 s51, 0x00020000
    v_lshrrev_b32 v6, 5, v0
    v_lshlrev_b32 v6, 2, v6
    v_bfe_u32 v7, v0, 2, 2
    v_add_u32 v6, v6, v7
    v_lshlrev_b32 v6, 7, v6
    v_and_b32 v7, 16, v0
    v_and_b32 v43, 3, v0
    v_lshl_add_u32 v7, v43, 2, v7
    v_lshl_add_u32 v6, v7, 1, v6
    s_and_b32 s3, s23, 1
    s_mul_i32 s3, s3, 28672
    v_add_u32 v6, s3, v6
    v_mov_b32 v4, 163584
bg_opub:
    ds_read_b32 v5, v4 offset:24
    s_waitcnt lgkmcnt(0)
    v_readfirstlane_b32 s3, v5
    s_cmp_ge_u32 s3, 8
    s_cbranch_scc1 bg_opub_ok
    s_sleep 1
    s_sub_u32 s18, s18, 1
    s_cbranch_scc0 bg_opub
    s_mov_b32 s18, 0
bg_opub_ok:
    s_mov_b32 s28, s72
    s_mov_b32 s29, s73
    s_mov_b32 s30, 0x62000
    s_mov_b32 s31, 0x00020000
    v_lshrrev_b32 v48, 3, v0
    v_mul_u32_u24 v48, 896, v48
    v_and_b32 v49, 7, v0
    v_lshl_add_u32 v48, v49, 4, v48
    s_mul_i32 s32, s23, 100352
    s_lshl_b32 s3, s21, 7
    s_add_u32 s32, s32, s3
    s_mul_i32 s34, s23, 14336
    s_mov_b32 m0, s34
    s_mov_b32 s36, 14
bg_wodma:
    s_sub_u32 s36, s36, 1
    buffer_load_dwordx4 v48, s[28:31], s32 offen lds
    s_add_u32 s32, s32, 7168
    s_add_u32 m0, m0, 1024
    s_cmp_lg_u32 s36, 0
    s_cbranch_scc1 bg_wodma
    v_mov_b32 v50, 0
    v_mov_b32 v51, 0
    v_lshlrev_b32 v49, 3, v0
    ds_write_b64 v49, v[50:51] offset:57344
    s_waitcnt vmcnt(0)
    s_setprio 3
    v_mov_b32 v4, 163584
    s_add_u32 s44, s44, 4
    v_mov_b32 v5, 1
    s_waitcnt lgkmcnt(0)
    s_mov_b64 exec, 1
    ds_add_u32 v4, v5 offset:4
    s_mov_b64 exec, -1
bg_bar7:
    ds_read_b32 v5, v4 offset:4
    s_waitcnt lgkmcnt(0)
    v_readfirstlane_b32 s3, v5
    s_cmp_ge_u32 s3, s44
    s_cbranch_scc1 bg_bar7_ok
    s_sleep 1
    s_sub_u32 s18, s18, 1
    s_cbranch_scc0 bg_bar7
    s_mov_b32 s18, 0
bg_bar7_ok:
    v_lshlrev_b32 v46, 2, v0
    s_lshl_b32 s35, s20, 7
    s_add_u32 s35, s35, 274432
    s_mov_b64 s[58:59], 0xff
bg_pollO:
    buffer_load_dword v47, v46, s[24:27], s35 offen sc1
    s_waitcnt vmcnt(0)
    v_cmp_ne_u32 vcc, s19, v47
    s_and_b64 vcc, vcc, s[58:59]
    s_cbranch_vccz bg_pollO_ok
    s_sleep 8
    s_sub_u32 s18, s18, 1
    s_cbranch_scc0 bg_pollO
    s_mov_b32 s18, 0
bg_pollO_ok:
    s_lshl_b32 s3, s20, 1
    s_add_u32 s3, s3, s38
    s_lshl_b32 s3, s3, 15
    s_and_b32 s33, s23, 1
    s_lshl_b32 s33, s33, 14
    s_add_u32 s3, s3, s33
    s_add_u32 s32, s3, 524288
    s_add_u32 s33, s32, 0
    buffer_load_dwordx4 v[88:91], v1, s[24:27], s33 offen sc1
    s_add_u32 s33, s32, 1024
    buffer_load_dwordx4 v[92:95], v1, s[24:27], s33 offen sc1
    s_add_u32 s33, s32, 2048
    buffer_load_dwordx4 v[96:99], v1, s[24:27], s33 offen sc1
    s_add_u32 s33, s32, 3072
    buffer_load_dwordx4 v[100:103], v1, s[24:27], s33 offen sc1
    s_add_u32 s33, s32, 4096
    buffer_load_dwordx4 v[104:107], v1, s[24:27], s33 offen sc1
    s_add_u32 s33, s32, 5120
    buffer_load_dwordx4 v[108:111], v1, s[24:27], s33 offen sc1
    s_add_u32 s33, s32, 6144
    buffer_load_dwordx4 v[112:115], v1, s[24:27], s33 offen sc1
    s_add_u32 s33, s32, 7168
    buffer_load_dwordx4 v[116:119], v1, s[24:27], s33 offen sc1
    s_add_u32 s33, s32, 8192
    buffer_load_dwordx4 v[120:123], v1, s[24:27], s33 offen sc1
    s_add_u32 s33, s32, 9216
    buffer_load_dwordx4 v[124:127], v1, s[24:27], s33 offen sc1
    s_add_u32 s33, s32, 10240
    buffer_load_dwordx4 v[128:131], v1, s[24:27], s33 offen sc1
    s_add_u32 s33, s32, 11264
    buffer_load_dwordx4 v[132:135], v1, s[24:27], s33 offen sc1
    s_add_u32 s33, s32, 12288
    buffer_load_dwordx4 v[136:139], v1, s[24:27], s33 offen sc1
    s_add_u32 s33, s32, 13312
    buffer_load_dwordx4 v[140:143], v1, s[24:27], s33 offen sc1
    s_add_u32 s33, s32, 14336
    buffer_load_dwordx4 v[144:147], v1, s[24:27], s33 offen sc1
    s_add_u32 s33, s32, 15360
    buffer_load_dwordx4 v[148:151], v1, s[24:27], s33 offen sc1
    ds_read_b64_tr_b16 v[24:25], v6 offset:0
    ds_read_b64_tr_b16 v[26:27], v6 offset:1024
    ds_read_b64_tr_b16 v[28:29], v6 offset:64
    ds_read_b64_tr_b16 v[30:31], v6 offset:1088
    ds_read_b64_tr_b16 v[32:33], v6 offset:2048
    ds_read_b64_tr_b16 v[34:35], v6 offset:3072
    ds_read_b64_tr_b16 v[36:37], v6 offset:2112
    ds_read_b64_tr_b16 v[38:39], v6 offset:3136
    s_waitcnt vmcnt(15) lgkmcnt(4)
    v_mfma_f32_32x32x16_bf16 v[56:71], v[88:91], v[24:27], 0
    v_mfma_f32_32x32x16_bf16 v[72:87], v[88:91], v[28:31], 0
    ds_read_b64_tr_b16 v[24:25], v6 offset:3584
    ds_read_b64_tr_b16 v[26:27], v6 offset:4608
    ds_read_b64_tr_b16 v[28:29], v6 offset:3648
    ds_read_b64_tr_b16 v[30:31], v6 offset:4672
    s_waitcnt vmcnt(14) lgkmcnt(4)
    v_mfma_f32_32x32x16_bf16 v[56:71], v[92:95], v[32:35], v[56:71]
    v_mfma_f32_32x32x16_bf16 v[72:87], v[92:95], v[36:39], v[72:87]
    ds_read_b64_tr_b16 v[32:33], v6 offset:5632
    ds_read_b64_tr_b16 v[34:35], v6 offset:6656
    ds_read_b64_tr_b16 v[36:37], v6 offset:5696
    ds_read_b64_tr_b16 v[38:39], v6 offset:6720
    s_waitcnt vmcnt(13) lgkmcnt(4)
    v_mfma_f32_32x32x16_bf16 v[56:71], v[96:99], v[24:27], v[56:71]
    v_mfma_f32_32x32x16_bf16 v[72:87], v[96:99], v[28:31], v[72:87]
    ds_read_b64_tr_b16 v[24:25], v6 offset:7168
    ds_read_b64_tr_b16 v[26:27], v6 offset:8192
    ds_read_b64_tr_b16 v[28:29], v6 offset:7232
    ds_read_b64_tr_b16 v[30:31], v6 offset:8256
    s_waitcnt vmcnt(12) lgkmcnt(4)
    v_mfma_f32_32x32x16_bf16 v[56:71], v[100:103], v[32:35], v[56:71]
    v_mfma_f32_32x32x16_bf16 v[72:87], v[100:103], v[36:39], v[72:87]
    ds_read_b64_tr_b16 v[32:33], v6 offset:9216
    ds_read_b64_tr_b16 v[34:35], v6 offset:10240
    ds_read_b64_tr_b16 v[36:37], v6 offset:9280
    ds_read_b64_tr_b16 v[38:39], v6 offset:10304
    s_waitcnt vmcnt(11) lgkmcnt(4)
    v_mfma_f32_32x32x16_bf16 v[56:71], v[104:107], v[24:27], v[56:71]
    v_mfma_f32_32x32x16_bf16 v[72:87], v[104:107], v[28:31], v[72:87]
    ds_read_b64_tr_b16 v[24:25], v6 offset:10752
    ds_read_b64_tr_b16 v[26:27], v6 offset:11776
    ds_read_b64_tr_b16 v[28:29], v6 offset:10816
    ds_read_b64_tr_b16 v[30:31], v6 offset:11840
    s_waitcnt vmcnt(10) lgkmcnt(4)
    v_mfma_f32_32x32x16_bf16 v[56:71], v[108:111], v[32:35], v[56:71]
    v_mfma_f32_32x32x16_bf16 v[72:87], v[108:111], v[36:39], v[72:87]
    ds_read_b64_tr_b16 v[32:33], v6 offset:12800
    ds_read_b64_tr_b16 v[34:35], v6 offset:13824
    ds_read_b64_tr_b16 v[36:37], v6 offset:12864
    ds_read_b64_tr_b16 v[38:39], v6 offset:13888
    s_waitcnt vmcnt(9) lgkmcnt(4)
    v_mfma_f32_32x32x16_bf16 v[56:71], v[112:115], v[24:27], v[56:71]
    v_mfma_f32_32x32x16_bf16 v[72:87], v[112:115], v[28:31], v[72:87]
    ds_read_b64_tr_b16 v[24:25], v6 offset:14336
    ds_read_b64_tr_b16 v[26:27], v6 offset:15360
    ds_read_b64_tr_b16 v[28:29], v6 offset:14400
    ds_read_b64_tr_b16 v[30:31], v6 offset:15424
    s_waitcnt vmcnt(8) lgkmcnt(4)
    v_mfma_f32_32x32x16_bf16 v[56:71], v[116:119], v[32:35], v[56:71]
    v_mfma_f32_32x32x16_bf16 v[72:87], v[116:119], v[36:39], v[72:87]
    ds_read_b64_tr_b16 v[32:33], v6 offset:16384
    ds_read_b64_tr_b16 v[34:35], v6 offset:17408
    ds_read_b64_tr_b16 v[36:37], v6 offset:16448
    ds_read_b64_tr_b16 v[38:39], v6 offset:17472
    s_waitcnt vmcnt(7) lgkmcnt(4)
    v_mfma_f32_32x32x16_bf16 v[56:71], v[120:123], v[24:27], v[56:71]
    v_mfma_f32_32x32x16_bf16 v[72:87], v[120:123], v[28:31], v[72:87]
    ds_read_b64_tr_b16 v[24:25], v6 offset:17920
    ds_read_b64_tr_b16 v[26:27], v6 offset:18944
    ds_read_b64_tr_b16 v[28:29], v6 offset:17984
    ds_read_b64_tr_b16 v[30:31], v6 offset:19008
    s_waitcnt vmcnt(6) lgkmcnt(4)
    v_mfma_f32_32x32x16_bf16 v[56:71], v[124:127], v[32:35], v[56:71]
    v_mfma_f32_32x32x16_bf16 v[72:87], v[124:127], v[36:39], v[72:87]
    ds_read_b64_tr_b16 v[32:33], v6 offset:19968
    ds_read_b64_tr_b16 v[34:35], v6 offset:20992
    ds_read_b64_tr_b16 v[36:37], v6 offset:20032
    ds_read_b64_tr_b16 v[38:39], v6 offset:21056
    s_waitcnt vmcnt(5) lgkmcnt(4)
    v_mfma_f32_32x32x16_bf16 v[56:71], v[128:131], v[24:27], v[56:71]
    v_mfma_f32_32x32x16_bf16 v[72:87], v[128:131], v[28:31], v[72:87]
    ds_read_b64_tr_b16 v[24:25], v6 offset:21504
    ds_read_b64_tr_b16 v[26:27], v6 offset:22528
    ds_read_b64_tr_b16 v[28:29], v6 offset:21568
    ds_read_b64_tr_b16 v[30:31], v6 offset:22592
    s_waitcnt vmcnt(4) lgkmcnt(4)
    v_mfma_f32_32x32x16_bf16 v[56:71], v[132:135], v[32:35], v[56:71]
    v_mfma_f32_32x32x16_bf16 v[72:87], v[132:135], v[36:39], v[72:87]
    ds_read_b64_tr_b16 v[32:33], v6 offset:23552
    ds_read_b64_tr_b16 v[34:35], v6 offset:24576
    ds_read_b64_tr_b16 v[36:37], v6 offset:23616
    ds_read_b64_tr_b16 v[38:39], v6 offset:24640
    s_waitcnt vmcnt(3) lgkmcnt(4)
    v_mfma_f32_32x32x16_bf16 v[56:71], v[136:139], v[24:27], v[56:71]
    v_mfma_f32_32x32x16_bf16 v[72:87], v[136:139], v[28:31], v[72:87]
    ds_read_b64_tr_b16 v[24:25], v6 offset:25088
    ds_read_b64_tr_b16 v[26:27], v6 offset:26112
    ds_read_b64_tr_b16 v[28:29], v6 offset:25152
    ds_read_b64_tr_b16 v[30:31], v6 offset:26176
    s_waitcnt vmcnt(2) lgkmcnt(4)
    v_mfma_f32_32x32x16_bf16 v[56:71], v[140:143], v[32:35], v[56:71]
    v_mfma_f32_32x32x16_bf16 v[72:87], v[140:143], v[36:39], v[72:87]
    ds_read_b64_tr_b16 v[32:33], v6 offset:27136
    ds_read_b64_tr_b16 v[34:35], v6 offset:28160
    ds_read_b64_tr_b16 v[36:37], v6 offset:27200
    ds_read_b64_tr_b16 v[38:39], v6 offset:28224
    s_waitcnt vmcnt(1) lgkmcnt(4)
    v_mfma_f32_32x32x16_bf16 v[56:71], v[144:147], v[24:27], v[56:71]
    v_mfma_f32_32x32x16_bf16 v[72:87], v[144:147], v[28:31], v[72:87]
    s_waitcnt vmcnt(0) lgkmcnt(0)
    v_mfma_f32_32x32x16_bf16 v[56:71], v[148:151], v[32:35], v[56:71]
    v_mfma_f32_32x32x16_bf16 v[72:87], v[148:151], v[36:39], v[72:87]
    s_xor_b32 s3, s23, 1
    s_lshl_b32 s3, s3, 12
    s_add_u32 s3, s3, 65536
    v_add_u32 v43, s3, v1
    s_and_b32 s33, s23, 1
    s_nop 7
    s_cmp_eq_u32 s33, 0
    s_cbranch_scc0 bg_send0
    ds_write_b128 v43, v[72:75] offset:0
    ds_write_b128 v43, v[76:79] offset:1024
    ds_write_b128 v43, v[80:83] offset:2048
    ds_write_b128 v43, v[84:87] offset:3072
    s_branch bg_sent
bg_send0:
    s_nop 1
    ds_write_b128 v43, v[56:59] offset:0
    ds_write_b128 v43, v[60:63] offset:1024
    ds_write_b128 v43, v[64:67] offset:2048
    ds_write_b128 v43, v[68:71] offset:3072
    s_nop 1
    v_mov_b32 v56, v72
    v_mov_b32 v57, v73
    v_mov_b32 v58, v74
    v_mov_b32 v59, v75
    v_mov_b32 v60, v76
    v_mov_b32 v61, v77
    v_mov_b32 v62, v78
    v_mov_b32 v63, v79
    v_mov_b32 v64, v80
    v_mov_b32 v65, v81
    v_mov_b32 v66, v82
    v_mov_b32 v67, v83
    v_mov_b32 v68, v84
    v_mov_b32 v69, v85
    v_mov_b32 v70, v86
    v_mov_b32 v71, v87
bg_sent:
    v_mov_b32 v4, 163584
    s_add_u32 s44, s44, 4
    v_mov_b32 v5, 1
    s_waitcnt lgkmcnt(0)
    s_mov_b64 exec, 1
    ds_add_u32 v4, v5 offset:4
    s_mov_b64 exec, -1
bg_bar8:
    ds_read_b32 v5, v4 offset:4
    s_waitcnt lgkmcnt(0)
    v_readfirstlane_b32 s3, v5
    s_cmp_ge_u32 s3, s44
    s_cbranch_scc1 bg_bar8_ok
    s_sleep 1
    s_sub_u32 s18, s18, 1
    s_cbranch_scc0 bg_bar8
    s_mov_b32 s18, 0
bg_bar8_ok:
    s_lshl_b32 s3, s23, 12
    s_add_u32 s3, s3, 65536
    v_add_u32 v43, s3, v1
    ds_read_b128 v[88:91], v43 offset:0
    ds_read_b128 v[92:95], v43 offset:1024
    ds_read_b128 v[96:99], v43 offset:2048
    ds_read_b128 v[100:103], v43 offset:3072
    s_waitcnt lgkmcnt(0)
    v_add_f32 v88, v88, v56
    v_fma_f32 v88, v152, v88, v8
    v_add_f32 v89, v89, v57
    v_fma_f32 v89, v153, v89, v9
    v_add_f32 v90, v90, v58
    v_fma_f32 v90, v154, v90, v10
    v_add_f32 v91, v91, v59
    v_fma_f32 v91, v155, v91, v11
    v_add_f32 v92, v92, v60
    v_fma_f32 v92, v156, v92, v12
    v_add_f32 v93, v93, v61
    v_fma_f32 v93, v157, v93, v13
    v_add_f32 v94, v94, v62
    v_fma_f32 v94, v158, v94, v14
    v_add_f32 v95, v95, v63
    v_fma_f32 v95, v159, v95, v15
    v_add_f32 v96, v96, v64
    v_fma_f32 v96, v160, v96, v16
    v_add_f32 v97, v97, v65
    v_fma_f32 v97, v161, v97, v17
    v_add_f32 v98, v98, v66
    v_fma_f32 v98, v162, v98, v18
    v_add_f32 v99, v99, v67
    v_fma_f32 v99, v163, v99, v19
    v_add_f32 v100, v100, v68
    v_fma_f32 v100, v164, v100, v20
    v_add_f32 v101, v101, v69
    v_fma_f32 v101, v165, v101, v21
    v_add_f32 v102, v102, v70
    v_fma_f32 v102, v166, v102, v22
    v_add_f32 v103, v103, v71
    v_fma_f32 v103, v167, v103, v23
    buffer_store_dword v88, v42, s[48:51], 0 offen offset:0 sc1
    buffer_store_dword v89, v42, s[48:51], 0 offen offset:1792 sc1
    v_add_u32 v42, 3584, v42
    buffer_store_dword v90, v42, s[48:51], 0 offen offset:0 sc1
    buffer_store_dword v91, v42, s[48:51], 0 offen offset:1792 sc1
    v_add_u32 v42, 3584, v42
    buffer_store_dword v92, v42, s[48:51], 0 offen offset:0 sc1
    buffer_store_dword v93, v42, s[48:51], 0 offen offset:1792 sc1
    v_add_u32 v42, 3584, v42
    buffer_store_dword v94, v42, s[48:51], 0 offen offset:0 sc1
    buffer_store_dword v95, v42, s[48:51], 0 offen offset:1792 sc1
    v_add_u32 v42, 3584, v42
    buffer_store_dword v96, v42, s[48:51], 0 offen offset:0 sc1
    buffer_store_dword v97, v42, s[48:51], 0 offen offset:1792 sc1
    v_add_u32 v42, 3584, v42
    buffer_store_dword v98, v42, s[48:51], 0 offen offset:0 sc1
    buffer_store_dword v99, v42, s[48:51], 0 offen offset:1792 sc1
    v_add_u32 v42, 3584, v42
    buffer_store_dword v100, v42, s[48:51], 0 offen offset:0 sc1
    buffer_store_dword v101, v42, s[48:51], 0 offen offset:1792 sc1
    v_add_u32 v42, 3584, v42
    buffer_store_dword v102, v42, s[48:51], 0 offen offset:0 sc1
    buffer_store_dword v103, v42, s[48:51], 0 offen offset:1792 sc1
    s_branch bg_end
bg_skip:
    v_mov_b32 v16, 163584
    v_mov_b32 v17, 1
    s_mov_b64 exec, 1
    ds_add_u32 v16, v17 offset:84
    s_mov_b64 exec, -1
    s_cmp_eq_u32 s17, 0
    s_cbranch_scc1 bg_sw0
    s_waitcnt vmcnt(2)
bg_sw0:
    s_cmp_lg_u32 s17, 0
    s_cbranch_scc1 bg_sw1
    s_waitcnt vmcnt(0)
bg_sw1:
    v_mov_b32 v16, 163584
    v_mov_b32 v17, 1
    s_mov_b64 exec, 1
    ds_add_u32 v16, v17 offset:88
    s_mov_b64 exec, -1
    v_mov_b32 v16, 163584
bg_sqd:
    ds_read_b32 v17, v16 offset:96
    s_waitcnt lgkmcnt(0)
    v_readfirstlane_b32 s3, v17
    s_cmp_ge_u32 s3, 4
    s_cbranch_scc1 bg_sqd_ok
    s_sleep 4
    s_sub_u32 s18, s18, 1
    s_cbranch_scc0 bg_sqd
    s_mov_b32 s18, 0
bg_sqd_ok:
    s_cmp_eq_u32 s23, 3
    s_cbranch_scc0 bg_noib
    s_mov_b32 s48, s96
    s_mov_b32 s49, s97
    s_mov_b32 s50, 0x100
    s_mov_b32 s51, 0x00020000
    v_mov_b32 v21, 0
    buffer_load_dword v22, v21, s[48:51], 0 offen offset:140 sc1
bg_noib:
    s_waitcnt vmcnt(0)
    s_cmp_eq_u32 s23, 3
    s_cbranch_scc0 bg_nonb
    s_mov_b32 s48, s96
    s_mov_b32 s49, s97
    s_mov_b32 s50, 0x100
    s_mov_b32 s51, 0x00020000
bg_npb:
    v_readfirstlane_b32 s3, v22
    s_cmp_lg_u32 s3, 0
    s_cbranch_scc1 bg_npokb
    s_sleep 8
    v_mov_b32 v21, 0
    buffer_load_dword v22, v21, s[48:51], 0 offen offset:140 sc1
    s_waitcnt vmcnt(0)
    s_sub_u32 s18, s18, 1
    s_cbranch_scc0 bg_npb
    s_mov_b32 s18, 0
bg_npokb:
    v_mov_b32 v21, 163584
    ds_write_b32 v21, v22 offset:8
bg_nonb:
    s_waitcnt lgkmcnt(0)
    s_cmp_eq_u32 s23, 3
    s_cbranch_scc1 bg_not3b
    s_cmp_eq_u32 s23, 0
    s_cselect_b32 s56, s84, s86
    s_cselect_b32 s57, s85, s87
    s_cmp_eq_u32 s23, 2
    s_cselect_b32 s56, s72, s56
    s_cselect_b32 s57, s73, s57
    s_mov_b32 s48, s56
    s_mov_b32 s49, s57
    s_mov_b32 s50, 0x62000
    s_mov_b32 s51, 0x00020000
    s_lshr_b32 s3, s2, 3
    s_mul_i32 s3, s3, 12544
    v_lshlrev_b32 v158, 7, v0
    s_mov_b32 m0, 161792
    s_nop 0
    buffer_load_dword v158, s[48:51], s3 offen lds
    s_add_u32 s3, s3, 8192
    s_mov_b32 exec_hi, 3
    buffer_load_dword v158, s[48:51], s3 offen lds
    s_mov_b64 exec, -1
bg_not3b:
    v_mov_b32 v54, 163584
    v_mov_b32 v55, 1
    s_mov_b64 exec, 1
    ds_add_u32 v54, v55 offset:20
    s_mov_b64 exec, -1
bg_end:
L_end:
    s_endpgm
.section .rodata,"a"
.p2align 6
.amdhsa_kernel gated_mix__grouped_kv_mqa__ssm_conv_s5__prompt_kernel
  .amdhsa_next_free_vgpr 168
  .amdhsa_next_free_sgpr 102
  .amdhsa_accum_offset 168
  .amdhsa_group_segment_fixed_size 0
  .amdhsa_kernarg_size 144
  .amdhsa_user_sgpr_count 2
  .amdhsa_user_sgpr_kernarg_segment_ptr 1
  .amdhsa_system_sgpr_workgroup_id_x 1
.end_amdhsa_kernel
```
